```python
import torch

def _softmax(x, axis=-1):
    return torch.softmax(x, dim=axis)
def _gelu(x):
    return torch.nn.functional.gelu(x, approximate="tanh")
def _silu(x):
    return torch.nn.functional.silu(x)
def _sigmoid(x):
    return torch.sigmoid(x)
def _layernorm(x, axis=-1, eps=1e-5):
    m = x.mean(dim=axis, keepdim=True)
    v = x.var(dim=axis, keepdim=True, unbiased=False)
    return (x - m) / torch.sqrt(v + eps)
def _scatter_add(tgt, idx, src, axis=0):
    return tgt.clone().index_add_(axis, idx, src)
def _segment_sum(src, seg, n):
    out = torch.zeros((n,) + src.shape[1:], dtype=src.dtype)
    return out.index_add_(0, seg, src)
def _pad(x, pw):
    flat = tuple(v for pair in reversed(pw) for v in pair)
    return torch.nn.functional.pad(x, flat)

kernel_name = 'standalone__detection_seg_dino__vision'

def setup_inputs():

    _w = (lambda a: (lambda t: t.to(torch.bfloat16) if t.is_floating_point() else t)(torch.as_tensor(a)))
    H = W = (384 // 2) * 2
    C = 384
    Nq = 16
    sc = C ** -0.5
    return {
        "q": _w((lambda *s: torch.randn(*s, dtype=torch.bfloat16) * 0.05)(1, Nq, C)),
        "f0": _w((lambda *s: torch.randn(*s, dtype=torch.bfloat16) * 0.8)(1, H, W, C)),
        "f1": _w((lambda *s: torch.randn(*s, dtype=torch.bfloat16) * 0.8)(1, H // 2, W // 2, C)),
        "wq": _w((lambda *s: torch.randn(*s, dtype=torch.bfloat16) * 1.6)(C, C) * sc),
        "wk": _w((lambda *s: torch.randn(*s, dtype=torch.bfloat16) * 1.6)(C, C) * sc),
        "wv": _w((lambda *s: torch.randn(*s, dtype=torch.bfloat16) * 0.8)(C, C) * sc),
        "wo": _w((lambda *s: torch.randn(*s, dtype=torch.bfloat16) * 0.8)(C, C) * sc),
    }

def reference(q, f0, f1, wq, wk, wv, wo):
    B, H, W, C = f0.shape
    f1u = (lambda x, n, axis: torch.repeat_interleave(x, n, dim=axis))((lambda x, n, axis: torch.repeat_interleave(x, n, dim=axis))(f1, 2, axis=1), 2, axis=2)
    fused = f0 + f1u
    feats = _layernorm(fused.reshape(B, H * W, C), axis=-1)
    qn = _layernorm(q, axis=-1)
    Q = torch.einsum("bnc,cd->bnd", qn, wq)
    K = torch.einsum("bmc,cd->bmd", feats, wk)
    V = torch.einsum("bmc,cd->bmd", feats, wv)
    scale = C ** -0.5
    logits = torch.einsum("bnd,bmd->bnm", Q, K) * scale
    attn = _softmax(logits, axis=-1)
    ctx = torch.einsum("bnm,bmd->bnd", attn, V)
    return q + torch.einsum("bnd,dc->bnc", ctx, wo)
```

```asm
; @launch grid=(256,1,1) block=(256,1,1) lds=160256
.amdgcn_target "amdgcn-amd-amdhsa--gfx950"
.text
.globl standalone__detection_seg_dino__vision_kernel
.p2align 8
.type standalone__detection_seg_dino__vision_kernel,@function
standalone__detection_seg_dino__vision_kernel:
  s_cmp_ge_u32 s2, 256
  s_cbranch_scc1 standalone__detection_seg_dino__vision_kernel_done
  s_load_dwordx2 s[22:23], s[0:1], 72
  s_load_dwordx4 s[4:7], s[0:1], 8
  v_readfirstlane_b32 s20, v0
  v_and_b32 v0, 63, v0
  s_nop 2
  s_lshr_b32 s20, s20, 6
  s_mov_b32 s93, 0xff
  s_lshr_b32 s100, s2, 3
  s_lshl_b32 s100, s100, 2
  s_and_b32 s21, s2, 7
  s_add_u32 s100, s100, s21
  s_sub_u32 s101, s100, 4
  s_sub_u32 s3, s2, 12
  s_cmp_lt_u32 s2, 24
  s_cselect_b32 s101, s101, s3
  s_cselect_b32 s3, s21, 7
  s_mov_b32 s21, s101
  s_cmp_lt_u32 s3, 4
  s_cbranch_scc1 standalone__detection_seg_dino__vision_kernel_special
  s_min_u32 s97, s21, 188
  s_add_u32 s91, s21, s97
  s_add_u32 s91, s91, s20
  s_cmp_lt_u32 s21, 188
  s_cselect_b32 s97, 2, 1
  s_lshl_b32 s90, s21, 2
  s_add_u32 s90, s90, s20
  v_lshrrev_b32 v56, 4, v0
  v_and_b32 v57, 15, v0
  v_mul_u32_u24 v1, 1536, v56
  v_lshl_add_u32 v1, v57, 4, v1
  v_mul_u32_u24 v2, 768, v56
  v_lshl_add_u32 v2, v57, 4, v2
  v_lshlrev_b32 v3, 4, v0
  s_waitcnt lgkmcnt(0)
  s_mov_b32 s8, s4
  s_and_b32 s9, s5, 0xffff
  s_mov_b32 s10, 113246208
  s_mov_b32 s11, 0x20000
  s_mov_b32 s12, s6
  s_and_b32 s13, s7, 0xffff
  s_mov_b32 s14, 28311552
  s_mov_b32 s15, 0x20000
  s_mov_b32 s16, s22
  s_and_b32 s17, s23, 0xffff
  s_mov_b32 s18, 3407872
  s_mov_b32 s19, 0x20000
  s_load_dword s94, s[22:23], 0
  s_sub_u32 s91, s91, s90
  s_mov_b32 s96, -1
  s_cmp_lt_u32 s20, s97
  s_cselect_b32 s89, 0, 0xf149f2ca
  s_add_u32 s96, s96, 1
  s_mul_i32 s27, s96, 976
  s_add_u32 s27, s27, s90
  s_cmp_gt_u32 s96, 8
  s_cselect_b32 s28, 4294966752, 0
  s_add_u32 s27, s27, s28
  s_cmp_eq_u32 s96, 8
  s_cselect_b32 s28, s91, 0
  s_cselect_b32 s23, s89, 0
  s_add_u32 s27, s27, s28
  s_mul_i32 s24, s27, 3072
  s_mul_hi_u32 s28, s27, 89478486
  s_mul_i32 s29, s28, 48
  s_sub_u32 s29, s27, s29
  s_mul_i32 s25, s28, 589824
  s_mul_i32 s29, s29, 6144
  s_add_u32 s25, s25, s29
  s_add_u32 s26, s25, 294912
  s_cmp_ge_u32 s96, 10
  s_cselect_b32 s23, 1, s23
  s_cmp_eq_u32 s23, 0
  s_cselect_b32 s10, 113246208, 0
  s_cselect_b32 s14, 28311552, 0
  buffer_load_dwordx4 v[76:79], v2, s[12:15], s24 offen offset:0 nt
  buffer_load_dwordx4 v[88:91], v1, s[8:11], s25 offen offset:0 nt
  buffer_load_dwordx4 v[92:95], v1, s[8:11], s25 offen offset:768 nt
  buffer_load_dwordx4 v[96:99], v1, s[8:11], s26 offen offset:0 nt
  buffer_load_dwordx4 v[100:103], v1, s[8:11], s26 offen offset:768 nt
  buffer_load_dwordx4 v[80:83], v2, s[12:15], s24 offen offset:256 nt
  buffer_load_dwordx4 v[104:107], v1, s[8:11], s25 offen offset:256 nt
  s_waitcnt lgkmcnt(0)
  s_add_u32 s94, s94, 1
  s_and_b32 s95, s94, 0xff
  v_mov_b32 v8, s95
  s_lshr_b32 s4, s95, 0
  s_and_b32 s48, s4, 2
  s_lshl_b32 s48, s48, 15
  s_and_b32 s4, s4, 1
  s_or_b32 s4, s4, s48
  s_lshr_b32 s5, s95, 2
  s_and_b32 s48, s5, 2
  s_lshl_b32 s48, s48, 15
  s_and_b32 s5, s5, 1
  s_or_b32 s5, s5, s48
  s_lshr_b32 s6, s95, 4
  s_and_b32 s48, s6, 2
  s_lshl_b32 s48, s48, 15
  s_and_b32 s6, s6, 1
  s_or_b32 s6, s6, s48
  s_lshr_b32 s7, s95, 6
  s_and_b32 s48, s7, 2
  s_lshl_b32 s48, s48, 15
  s_and_b32 s7, s7, 1
  s_or_b32 s7, s7, s48
  s_mul_i32 s47, s20, 12288
  v_and_b32 v58, 1, v56
  v_lshlrev_b32 v58, 3, v58
  v_lshrrev_b32 v59, 1, v56
  v_add_u32 v58, v58, v59
  v_xor_b32 v58, v58, v57
  v_lshlrev_b32 v58, 4, v58
  v_mul_u32_u24 v59, 3072, v56
  v_add_u32 v58, v58, v59
  v_add_u32 v4, s47, v58
  v_xor_b32 v5, 32, v4
  v_xor_b32 v6, 64, v4
  v_xor_b32 v7, 96, v4
  v_add_u32 v236, 98304, v4
  v_add_u32 v237, 98304, v5
  v_add_u32 v238, 98304, v6
  v_add_u32 v239, 98304, v7
  v_and_b32 v58, 7, v57
  v_lshlrev_b32 v58, 1, v58
  v_lshrrev_b32 v59, 3, v57
  v_or_b32 v58, v58, v59
  v_lshlrev_b32 v59, 1, v56
  v_xor_b32 v59, v59, v58
  v_mul_u32_u24 v60, 768, v57
  v_add_u32 v60, s47, v60
  v_xor_b32 v11, 0, v59
  v_lshl_add_u32 v11, v11, 4, v60
  v_add_u32 v29, 98304, v11
  v_xor_b32 v12, 1, v59
  v_lshl_add_u32 v12, v12, 4, v60
  v_add_u32 v30, 98304, v12
  v_xor_b32 v13, 8, v59
  v_lshl_add_u32 v13, v13, 4, v60
  v_add_u32 v31, 98304, v13
  v_xor_b32 v14, 9, v59
  v_lshl_add_u32 v14, v14, 4, v60
  v_add_u32 v10, 98304, v14
  v_lshlrev_b32 v22, 4, v57
  v_lshrrev_b32 v59, 1, v56
  v_lshlrev_b32 v59, 10, v59
  v_and_b32 v60, 1, v56
  v_lshl_add_u32 v59, v60, 3, v59
  v_add_u32 v59, v59, v22
  v_add_u32 v9, 147968, v59
  v_add_u32 v22, 147456, v22
  s_lshl_b32 s48, s20, 2
  v_add_u32 v21, s48, v22
  v_add_u32 v24, 147968, v3
  s_lshr_b32 s48, s20, 1
  s_lshl_b32 s48, s48, 10
  s_and_b32 s49, s20, 1
  s_lshl_b32 s49, s49, 3
  s_add_u32 s48, s48, s49
  v_add_u32 v23, s48, v24
  v_lshrrev_b32 v56, 2, v0
  v_and_b32 v58, 7, v56
  v_lshlrev_b32 v58, 1, v58
  v_lshrrev_b32 v59, 3, v56
  v_or_b32 v58, v58, v59
  v_and_b32 v59, 3, v0
  v_lshrrev_b32 v60, 1, v59
  v_xor_b32 v58, v58, v60
  v_and_b32 v59, 1, v59
  v_lshlrev_b32 v59, 3, v59
  v_mul_u32_u24 v60, 768, v56
  v_add_u32 v60, v60, v59
  s_mul_i32 s48, s20, 6
  s_add_u32 s49, s48, 0
  s_and_b32 s50, s49, 7
  s_lshl_b32 s50, s50, 1
  s_lshr_b32 s49, s49, 3
  s_lshl_b32 s49, s49, 8
  v_xor_b32 v15, s50, v58
  v_lshl_add_u32 v15, v15, 4, v60
  v_add_u32 v15, s49, v15
  s_add_u32 s49, s48, 1
  s_and_b32 s50, s49, 7
  s_lshl_b32 s50, s50, 1
  s_lshr_b32 s49, s49, 3
  s_lshl_b32 s49, s49, 8
  v_xor_b32 v16, s50, v58
  v_lshl_add_u32 v16, v16, 4, v60
  v_add_u32 v16, s49, v16
  s_add_u32 s49, s48, 2
  s_and_b32 s50, s49, 7
  s_lshl_b32 s50, s50, 1
  s_lshr_b32 s49, s49, 3
  s_lshl_b32 s49, s49, 8
  v_xor_b32 v17, s50, v58
  v_lshl_add_u32 v17, v17, 4, v60
  v_add_u32 v17, s49, v17
  s_add_u32 s49, s48, 3
  s_and_b32 s50, s49, 7
  s_lshl_b32 s50, s50, 1
  s_lshr_b32 s49, s49, 3
  s_lshl_b32 s49, s49, 8
  v_xor_b32 v18, s50, v58
  v_lshl_add_u32 v18, v18, 4, v60
  v_add_u32 v18, s49, v18
  s_add_u32 s49, s48, 4
  s_and_b32 s50, s49, 7
  s_lshl_b32 s50, s50, 1
  s_lshr_b32 s49, s49, 3
  s_lshl_b32 s49, s49, 8
  v_xor_b32 v19, s50, v58
  v_lshl_add_u32 v19, v19, 4, v60
  v_add_u32 v19, s49, v19
  s_add_u32 s49, s48, 5
  s_and_b32 s50, s49, 7
  s_lshl_b32 s50, s50, 1
  s_lshr_b32 s49, s49, 3
  s_lshl_b32 s49, s49, 8
  v_xor_b32 v20, s50, v58
  v_lshl_add_u32 v20, v20, 4, v60
  v_add_u32 v20, s49, v20
  s_mov_b32 s30, 0x00100001
  s_mov_b32 s31, 0x10000100
  s_mov_b32 s32, 0x00200002
  s_mov_b32 s33, 0x20000200
  s_mov_b32 s34, 0x00400004
  s_mov_b32 s35, 0x40000400
  s_mov_b32 s36, 0x00800008
  s_mov_b32 s37, 0x80000800
  s_mov_b32 s38, 0x22222222
  s_mov_b32 s39, 0x22222222
  s_mov_b32 s40, 0x44444444
  s_mov_b32 s41, 0x44444444
  s_mov_b32 s42, 0x88888888
  s_mov_b32 s43, 0x88888888
  s_mov_b32 s44, 0xffff0000
  s_mov_b32 s87, 0xffffff00
  s_mov_b32 s45, 0x3b2aaaab
  s_mov_b32 s46, 0x3727c5ac
  s_mov_b32 s51, 0x00003f80
  s_mov_b32 s3, 0x3f800000
  v_mov_b32 v32, 0
  v_mov_b32 v33, 0
  v_mov_b32 v34, 0
  v_mov_b32 v35, 0
  v_mov_b32 v36, 0
  v_mov_b32 v37, 0
  v_mov_b32 v38, 0
  v_mov_b32 v39, 0
  v_mov_b32 v40, 0
  v_mov_b32 v41, 0
  v_mov_b32 v42, 0
  v_mov_b32 v43, 0
  v_mov_b32 v44, 0
  v_mov_b32 v45, 0
  v_mov_b32 v46, 0
  v_mov_b32 v47, 0
  v_mov_b32 v48, 0
  v_mov_b32 v49, 0
  v_mov_b32 v50, 0
  v_mov_b32 v51, 0
  v_mov_b32 v52, 0
  v_mov_b32 v53, 0
  v_mov_b32 v54, 0
  v_mov_b32 v55, 0
  v_mov_b32 v25, 0xf149f2ca
  v_mov_b32 v26, 0
  v_mov_b32 v27, 0
  v_mov_b32 v56, 0x3f803f80
  v_accvgpr_write_b32 a192, v56
  v_accvgpr_write_b32 a193, v56
  v_accvgpr_write_b32 a194, v56
  v_accvgpr_write_b32 a195, v56
  buffer_load_dwordx4 v[108:111], v1, s[8:11], s25 offen offset:1024 nt
  s_waitcnt vmcnt(7)
  v_lshlrev_b32 v196, 16, v76
  v_and_b32 v197, s44, v76
  v_lshlrev_b32 v198, 16, v77
  v_and_b32 v199, s44, v77
  v_lshlrev_b32 v200, 16, v78
  v_and_b32 v201, s44, v78
  v_lshlrev_b32 v202, 16, v79
  v_and_b32 v203, s44, v79
  buffer_load_dwordx4 v[112:115], v1, s[8:11], s26 offen offset:256 nt
  s_waitcnt vmcnt(7)
  v_dot2_f32_bf16 v204, v88, s51, v196
  v_dot2_f32_bf16 v205, v88, s3, v197
  v_dot2_f32_bf16 v206, v89, s51, v198
  v_dot2_f32_bf16 v207, v89, s3, v199
  v_dot2_f32_bf16 v208, v90, s51, v200
  v_dot2_f32_bf16 v209, v90, s3, v201
  v_dot2_f32_bf16 v210, v91, s51, v202
  v_dot2_f32_bf16 v211, v91, s3, v203
  v_cvt_pk_bf16_f32 v88, v204, v205
  v_cvt_pk_bf16_f32 v89, v206, v207
  v_cvt_pk_bf16_f32 v90, v208, v209
  v_cvt_pk_bf16_f32 v91, v210, v211
  ds_write_b128 v4, v[88:91] offset:0
  buffer_load_dwordx4 v[116:119], v1, s[8:11], s26 offen offset:1024 nt
  s_waitcnt vmcnt(7)
  v_dot2_f32_bf16 v204, v92, s51, v196
  v_dot2_f32_bf16 v205, v92, s3, v197
  v_dot2_f32_bf16 v206, v93, s51, v198
  v_dot2_f32_bf16 v207, v93, s3, v199
  v_dot2_f32_bf16 v208, v94, s51, v200
  v_dot2_f32_bf16 v209, v94, s3, v201
  v_dot2_f32_bf16 v210, v95, s51, v202
  v_dot2_f32_bf16 v211, v95, s3, v203
  v_cvt_pk_bf16_f32 v92, v204, v205
  v_cvt_pk_bf16_f32 v93, v206, v207
  v_cvt_pk_bf16_f32 v94, v208, v209
  v_cvt_pk_bf16_f32 v95, v210, v211
  ds_write_b128 v5, v[92:95] offset:768
  buffer_load_dwordx4 v[84:87], v2, s[12:15], s24 offen offset:512 nt
  s_waitcnt vmcnt(7)
  v_dot2_f32_bf16 v204, v96, s51, v196
  v_dot2_f32_bf16 v205, v96, s3, v197
  v_dot2_f32_bf16 v206, v97, s51, v198
  v_dot2_f32_bf16 v207, v97, s3, v199
  v_dot2_f32_bf16 v208, v98, s51, v200
  v_dot2_f32_bf16 v209, v98, s3, v201
  v_dot2_f32_bf16 v210, v99, s51, v202
  v_dot2_f32_bf16 v211, v99, s3, v203
  v_cvt_pk_bf16_f32 v96, v204, v205
  v_cvt_pk_bf16_f32 v97, v206, v207
  v_cvt_pk_bf16_f32 v98, v208, v209
  v_cvt_pk_bf16_f32 v99, v210, v211
  ds_write_b128 v6, v[96:99] offset:1536
  buffer_load_dwordx4 v[120:123], v1, s[8:11], s25 offen offset:512 nt
  s_waitcnt vmcnt(7)
  v_dot2_f32_bf16 v204, v100, s51, v196
  v_dot2_f32_bf16 v205, v100, s3, v197
  v_dot2_f32_bf16 v206, v101, s51, v198
  v_dot2_f32_bf16 v207, v101, s3, v199
  v_dot2_f32_bf16 v208, v102, s51, v200
  v_dot2_f32_bf16 v209, v102, s3, v201
  v_dot2_f32_bf16 v210, v103, s51, v202
  v_dot2_f32_bf16 v211, v103, s3, v203
  v_cvt_pk_bf16_f32 v100, v204, v205
  v_cvt_pk_bf16_f32 v101, v206, v207
  v_cvt_pk_bf16_f32 v102, v208, v209
  v_cvt_pk_bf16_f32 v103, v210, v211
  ds_write_b128 v7, v[100:103] offset:2304
  buffer_load_dwordx4 v[124:127], v1, s[8:11], s25 offen offset:1280 nt
  s_waitcnt vmcnt(7)
  v_lshlrev_b32 v196, 16, v80
  v_and_b32 v197, s44, v80
  v_lshlrev_b32 v198, 16, v81
  v_and_b32 v199, s44, v81
  v_lshlrev_b32 v200, 16, v82
  v_and_b32 v201, s44, v82
  v_lshlrev_b32 v202, 16, v83
  v_and_b32 v203, s44, v83
  buffer_load_dwordx4 v[128:131], v1, s[8:11], s26 offen offset:512 nt
  s_waitcnt vmcnt(7)
  v_dot2_f32_bf16 v204, v104, s51, v196
  v_dot2_f32_bf16 v205, v104, s3, v197
  v_dot2_f32_bf16 v206, v105, s51, v198
  v_dot2_f32_bf16 v207, v105, s3, v199
  v_dot2_f32_bf16 v208, v106, s51, v200
  v_dot2_f32_bf16 v209, v106, s3, v201
  v_dot2_f32_bf16 v210, v107, s51, v202
  v_dot2_f32_bf16 v211, v107, s3, v203
  v_cvt_pk_bf16_f32 v104, v204, v205
  v_cvt_pk_bf16_f32 v105, v206, v207
  v_cvt_pk_bf16_f32 v106, v208, v209
  v_cvt_pk_bf16_f32 v107, v210, v211
  ds_write_b128 v4, v[104:107] offset:256
  buffer_load_dwordx4 v[132:135], v1, s[8:11], s26 offen offset:1280 nt
  s_waitcnt vmcnt(7)
  v_dot2_f32_bf16 v204, v108, s51, v196
  v_dot2_f32_bf16 v205, v108, s3, v197
  v_dot2_f32_bf16 v206, v109, s51, v198
  v_dot2_f32_bf16 v207, v109, s3, v199
  v_dot2_f32_bf16 v208, v110, s51, v200
  v_dot2_f32_bf16 v209, v110, s3, v201
  v_dot2_f32_bf16 v210, v111, s51, v202
  v_dot2_f32_bf16 v211, v111, s3, v203
  v_cvt_pk_bf16_f32 v108, v204, v205
  v_cvt_pk_bf16_f32 v109, v206, v207
  v_cvt_pk_bf16_f32 v110, v208, v209
  v_cvt_pk_bf16_f32 v111, v210, v211
  ds_write_b128 v5, v[108:111] offset:1024
  s_add_u32 s96, s96, 1
  s_mul_i32 s27, s96, 976
  s_add_u32 s27, s27, s90
  s_cmp_gt_u32 s96, 8
  s_cselect_b32 s28, 4294966752, 0
  s_add_u32 s27, s27, s28
  s_cmp_eq_u32 s96, 8
  s_cselect_b32 s28, s91, 0
  s_cselect_b32 s23, s89, 0
  s_add_u32 s27, s27, s28
  s_mul_i32 s24, s27, 3072
  s_mul_hi_u32 s28, s27, 89478486
  s_mul_i32 s29, s28, 48
  s_sub_u32 s29, s27, s29
  s_mul_i32 s25, s28, 589824
  s_mul_i32 s29, s29, 6144
  s_add_u32 s25, s25, s29
  s_add_u32 s26, s25, 294912
  s_cmp_ge_u32 s96, 10
  s_cselect_b32 s23, 1, s23
  s_cmp_eq_u32 s23, 0
  s_cselect_b32 s10, 113246208, 0
  s_cselect_b32 s14, 28311552, 0
  buffer_load_dwordx4 v[136:139], v2, s[12:15], s24 offen offset:0 nt
  s_waitcnt vmcnt(7)
  v_dot2_f32_bf16 v204, v112, s51, v196
  v_dot2_f32_bf16 v205, v112, s3, v197
  v_dot2_f32_bf16 v206, v113, s51, v198
  v_dot2_f32_bf16 v207, v113, s3, v199
  v_dot2_f32_bf16 v208, v114, s51, v200
  v_dot2_f32_bf16 v209, v114, s3, v201
  v_dot2_f32_bf16 v210, v115, s51, v202
  v_dot2_f32_bf16 v211, v115, s3, v203
  v_cvt_pk_bf16_f32 v112, v204, v205
  v_cvt_pk_bf16_f32 v113, v206, v207
  v_cvt_pk_bf16_f32 v114, v208, v209
  v_cvt_pk_bf16_f32 v115, v210, v211
  ds_write_b128 v6, v[112:115] offset:1792
  buffer_load_dwordx4 v[148:151], v1, s[8:11], s25 offen offset:0 nt
  s_waitcnt vmcnt(7)
  v_dot2_f32_bf16 v204, v116, s51, v196
  v_dot2_f32_bf16 v205, v116, s3, v197
  v_dot2_f32_bf16 v206, v117, s51, v198
  v_dot2_f32_bf16 v207, v117, s3, v199
  v_dot2_f32_bf16 v208, v118, s51, v200
  v_dot2_f32_bf16 v209, v118, s3, v201
  v_dot2_f32_bf16 v210, v119, s51, v202
  v_dot2_f32_bf16 v211, v119, s3, v203
  v_cvt_pk_bf16_f32 v116, v204, v205
  v_cvt_pk_bf16_f32 v117, v206, v207
  v_cvt_pk_bf16_f32 v118, v208, v209
  v_cvt_pk_bf16_f32 v119, v210, v211
  ds_write_b128 v7, v[116:119] offset:2560
  buffer_load_dwordx4 v[152:155], v1, s[8:11], s25 offen offset:768 nt
  s_waitcnt vmcnt(7)
  v_lshlrev_b32 v196, 16, v84
  v_and_b32 v197, s44, v84
  v_lshlrev_b32 v198, 16, v85
  v_and_b32 v199, s44, v85
  v_lshlrev_b32 v200, 16, v86
  v_and_b32 v201, s44, v86
  v_lshlrev_b32 v202, 16, v87
  v_and_b32 v203, s44, v87
  buffer_load_dwordx4 v[156:159], v1, s[8:11], s26 offen offset:0 nt
  s_waitcnt vmcnt(7)
  v_dot2_f32_bf16 v204, v120, s51, v196
  v_dot2_f32_bf16 v205, v120, s3, v197
  v_dot2_f32_bf16 v206, v121, s51, v198
  v_dot2_f32_bf16 v207, v121, s3, v199
  v_dot2_f32_bf16 v208, v122, s51, v200
  v_dot2_f32_bf16 v209, v122, s3, v201
  v_dot2_f32_bf16 v210, v123, s51, v202
  v_dot2_f32_bf16 v211, v123, s3, v203
  v_cvt_pk_bf16_f32 v120, v204, v205
  v_cvt_pk_bf16_f32 v121, v206, v207
  v_cvt_pk_bf16_f32 v122, v208, v209
  v_cvt_pk_bf16_f32 v123, v210, v211
  ds_write_b128 v4, v[120:123] offset:512
  buffer_load_dwordx4 v[160:163], v1, s[8:11], s26 offen offset:768 nt
  s_waitcnt vmcnt(7)
  v_dot2_f32_bf16 v204, v124, s51, v196
  v_dot2_f32_bf16 v205, v124, s3, v197
  v_dot2_f32_bf16 v206, v125, s51, v198
  v_dot2_f32_bf16 v207, v125, s3, v199
  v_dot2_f32_bf16 v208, v126, s51, v200
  v_dot2_f32_bf16 v209, v126, s3, v201
  v_dot2_f32_bf16 v210, v127, s51, v202
  v_dot2_f32_bf16 v211, v127, s3, v203
  v_cvt_pk_bf16_f32 v124, v204, v205
  v_cvt_pk_bf16_f32 v125, v206, v207
  v_cvt_pk_bf16_f32 v126, v208, v209
  v_cvt_pk_bf16_f32 v127, v210, v211
  ds_write_b128 v5, v[124:127] offset:1280
  buffer_load_dwordx4 v[140:143], v2, s[12:15], s24 offen offset:256 nt
  s_waitcnt vmcnt(7)
  v_dot2_f32_bf16 v204, v128, s51, v196
  v_dot2_f32_bf16 v205, v128, s3, v197
  v_dot2_f32_bf16 v206, v129, s51, v198
  v_dot2_f32_bf16 v207, v129, s3, v199
  v_dot2_f32_bf16 v208, v130, s51, v200
  v_dot2_f32_bf16 v209, v130, s3, v201
  v_dot2_f32_bf16 v210, v131, s51, v202
  v_dot2_f32_bf16 v211, v131, s3, v203
  v_cvt_pk_bf16_f32 v128, v204, v205
  v_cvt_pk_bf16_f32 v129, v206, v207
  v_cvt_pk_bf16_f32 v130, v208, v209
  v_cvt_pk_bf16_f32 v131, v210, v211
  ds_write_b128 v6, v[128:131] offset:2048
  buffer_load_dwordx4 v[164:167], v1, s[8:11], s25 offen offset:256 nt
  s_waitcnt vmcnt(7)
  v_dot2_f32_bf16 v204, v132, s51, v196
  v_dot2_f32_bf16 v205, v132, s3, v197
  v_dot2_f32_bf16 v206, v133, s51, v198
  v_dot2_f32_bf16 v207, v133, s3, v199
  v_dot2_f32_bf16 v208, v134, s51, v200
  v_dot2_f32_bf16 v209, v134, s3, v201
  v_dot2_f32_bf16 v210, v135, s51, v202
  v_dot2_f32_bf16 v211, v135, s3, v203
  v_cvt_pk_bf16_f32 v132, v204, v205
  v_cvt_pk_bf16_f32 v133, v206, v207
  v_cvt_pk_bf16_f32 v134, v208, v209
  v_cvt_pk_bf16_f32 v135, v210, v211
  ds_write_b128 v7, v[132:135] offset:2816
  ds_read_b128 a[48:51], v11 offset:0
  ds_read_b128 a[52:55], v12 offset:0
  ds_read_b128 a[56:59], v13 offset:0
  ds_read_b128 a[60:63], v14 offset:0
  ds_read_b128 a[64:67], v11 offset:256
  ds_read_b128 a[68:71], v12 offset:256
  ds_read_b128 a[72:75], v13 offset:256
  ds_read_b128 a[76:79], v14 offset:256
  ds_read_b128 a[80:83], v11 offset:512
  ds_read_b128 a[84:87], v12 offset:512
  ds_read_b128 a[88:91], v13 offset:512
  ds_read_b128 a[92:95], v14 offset:512
  s_waitcnt lgkmcnt(11)
  v_mfma_f32_16x16x32_bf16 v[60:63], a[48:51], a[48:51], 0
  v_mfma_f32_16x16x32_bf16 v[64:67], a[48:51], a[192:195], 0
  s_waitcnt lgkmcnt(10)
  v_mfma_f32_16x16x32_bf16 v[60:63], a[52:55], a[52:55], v[60:63]
  v_mfma_f32_16x16x32_bf16 v[64:67], a[52:55], a[192:195], v[64:67]
  s_waitcnt lgkmcnt(9)
  v_mfma_f32_16x16x32_bf16 v[60:63], a[56:59], a[56:59], v[60:63]
  v_mfma_f32_16x16x32_bf16 v[64:67], a[56:59], a[192:195], v[64:67]
  s_waitcnt lgkmcnt(8)
  v_mfma_f32_16x16x32_bf16 v[60:63], a[60:63], a[60:63], v[60:63]
  v_mfma_f32_16x16x32_bf16 v[64:67], a[60:63], a[192:195], v[64:67]
  s_waitcnt lgkmcnt(7)
  v_mfma_f32_16x16x32_bf16 v[60:63], a[64:67], a[64:67], v[60:63]
  v_mfma_f32_16x16x32_bf16 v[64:67], a[64:67], a[192:195], v[64:67]
  s_waitcnt lgkmcnt(6)
  v_mfma_f32_16x16x32_bf16 v[60:63], a[68:71], a[68:71], v[60:63]
  v_mfma_f32_16x16x32_bf16 v[64:67], a[68:71], a[192:195], v[64:67]
  s_waitcnt lgkmcnt(5)
  v_mfma_f32_16x16x32_bf16 v[60:63], a[72:75], a[72:75], v[60:63]
  v_mfma_f32_16x16x32_bf16 v[64:67], a[72:75], a[192:195], v[64:67]
  s_waitcnt lgkmcnt(4)
  v_mfma_f32_16x16x32_bf16 v[60:63], a[76:79], a[76:79], v[60:63]
  v_mfma_f32_16x16x32_bf16 v[64:67], a[76:79], a[192:195], v[64:67]
  s_waitcnt lgkmcnt(3)
  v_mfma_f32_16x16x32_bf16 v[60:63], a[80:83], a[80:83], v[60:63]
  v_mfma_f32_16x16x32_bf16 v[64:67], a[80:83], a[192:195], v[64:67]
  s_waitcnt lgkmcnt(2)
  v_mfma_f32_16x16x32_bf16 v[60:63], a[84:87], a[84:87], v[60:63]
  v_mfma_f32_16x16x32_bf16 v[64:67], a[84:87], a[192:195], v[64:67]
  s_waitcnt lgkmcnt(1)
  v_mfma_f32_16x16x32_bf16 v[60:63], a[88:91], a[88:91], v[60:63]
  v_mfma_f32_16x16x32_bf16 v[64:67], a[88:91], a[192:195], v[64:67]
  s_waitcnt lgkmcnt(0)
  v_mfma_f32_16x16x32_bf16 v[60:63], a[92:95], a[92:95], v[60:63]
  v_mfma_f32_16x16x32_bf16 v[64:67], a[92:95], a[192:195], v[64:67]
  s_nop 6
  v_cndmask_b32 v68, 0, v60, s[30:31]
  v_cndmask_b32 v68, v68, v61, s[32:33]
  v_cndmask_b32 v68, v68, v62, s[34:35]
  v_cndmask_b32 v68, v68, v63, s[36:37]
  v_cndmask_b32 v69, v64, v65, s[38:39]
  v_cndmask_b32 v69, v69, v66, s[40:41]
  v_add_f32_dpp v68, v68, v68 row_ror:4 row_mask:0xf bank_mask:0xf
  v_cndmask_b32 v69, v69, v67, s[42:43]
  v_mov_b32 v71, s46
  v_add_f32_dpp v68, v68, v68 row_ror:8 row_mask:0xf bank_mask:0xf
  v_mul_f32 v69, s45, v69
  v_fma_f32 v68, v68, s45, v71
  v_fma_f32 v68, -v69, v69, v68
  v_max_f32 v68, s46, v68
  v_rsq_f32 v70, v68
  buffer_load_dwordx4 v[168:171], v1, s[8:11], s25 offen offset:1024 nt
  s_waitcnt vmcnt(7)
  v_lshlrev_b32 v196, 16, v136
  v_and_b32 v197, s44, v136
  v_lshlrev_b32 v198, 16, v137
  v_and_b32 v199, s44, v137
  v_lshlrev_b32 v200, 16, v138
  v_and_b32 v201, s44, v138
  v_lshlrev_b32 v202, 16, v139
  v_and_b32 v203, s44, v139
  buffer_load_dwordx4 v[172:175], v1, s[8:11], s26 offen offset:256 nt
  s_waitcnt vmcnt(7)
  v_dot2_f32_bf16 v204, v148, s51, v196
  v_dot2_f32_bf16 v205, v148, s3, v197
  v_dot2_f32_bf16 v206, v149, s51, v198
  v_dot2_f32_bf16 v207, v149, s3, v199
  v_dot2_f32_bf16 v208, v150, s51, v200
  v_dot2_f32_bf16 v209, v150, s3, v201
  v_dot2_f32_bf16 v210, v151, s51, v202
  v_dot2_f32_bf16 v211, v151, s3, v203
  v_cvt_pk_bf16_f32 v148, v204, v205
  v_cvt_pk_bf16_f32 v149, v206, v207
  v_cvt_pk_bf16_f32 v150, v208, v209
  v_cvt_pk_bf16_f32 v151, v210, v211
  ds_write_b128 v4, v[148:151] offset:49152
  buffer_load_dwordx4 v[176:179], v1, s[8:11], s26 offen offset:1024 nt
  s_waitcnt vmcnt(7)
  v_dot2_f32_bf16 v204, v152, s51, v196
  v_dot2_f32_bf16 v205, v152, s3, v197
  v_dot2_f32_bf16 v206, v153, s51, v198
  v_dot2_f32_bf16 v207, v153, s3, v199
  v_dot2_f32_bf16 v208, v154, s51, v200
  v_dot2_f32_bf16 v209, v154, s3, v201
  v_dot2_f32_bf16 v210, v155, s51, v202
  v_dot2_f32_bf16 v211, v155, s3, v203
  v_cvt_pk_bf16_f32 v152, v204, v205
  v_cvt_pk_bf16_f32 v153, v206, v207
  v_cvt_pk_bf16_f32 v154, v208, v209
  v_cvt_pk_bf16_f32 v155, v210, v211
  ds_write_b128 v5, v[152:155] offset:49920
  buffer_load_dwordx4 v[144:147], v2, s[12:15], s24 offen offset:512 nt
  s_waitcnt vmcnt(7)
  v_dot2_f32_bf16 v204, v156, s51, v196
  v_dot2_f32_bf16 v205, v156, s3, v197
  v_dot2_f32_bf16 v206, v157, s51, v198
  v_dot2_f32_bf16 v207, v157, s3, v199
  v_dot2_f32_bf16 v208, v158, s51, v200
  v_dot2_f32_bf16 v209, v158, s3, v201
  v_dot2_f32_bf16 v210, v159, s51, v202
  v_dot2_f32_bf16 v211, v159, s3, v203
  v_cvt_pk_bf16_f32 v156, v204, v205
  v_cvt_pk_bf16_f32 v157, v206, v207
  v_cvt_pk_bf16_f32 v158, v208, v209
  v_cvt_pk_bf16_f32 v159, v210, v211
  ds_write_b128 v6, v[156:159] offset:50688
  buffer_load_dwordx4 v[180:183], v1, s[8:11], s25 offen offset:512 nt
  s_waitcnt vmcnt(7)
  v_dot2_f32_bf16 v204, v160, s51, v196
  v_dot2_f32_bf16 v205, v160, s3, v197
  v_dot2_f32_bf16 v206, v161, s51, v198
  v_dot2_f32_bf16 v207, v161, s3, v199
  v_dot2_f32_bf16 v208, v162, s51, v200
  v_dot2_f32_bf16 v209, v162, s3, v201
  v_dot2_f32_bf16 v210, v163, s51, v202
  v_dot2_f32_bf16 v211, v163, s3, v203
  v_cvt_pk_bf16_f32 v160, v204, v205
  v_cvt_pk_bf16_f32 v161, v206, v207
  v_cvt_pk_bf16_f32 v162, v208, v209
  v_cvt_pk_bf16_f32 v163, v210, v211
  ds_write_b128 v7, v[160:163] offset:51456
  buffer_load_dwordx4 v[184:187], v1, s[8:11], s25 offen offset:1280 nt
  s_waitcnt vmcnt(7)
  v_lshlrev_b32 v196, 16, v140
  v_and_b32 v197, s44, v140
  v_lshlrev_b32 v198, 16, v141
  v_and_b32 v199, s44, v141
  v_lshlrev_b32 v200, 16, v142
  v_and_b32 v201, s44, v142
  v_lshlrev_b32 v202, 16, v143
  v_and_b32 v203, s44, v143
  buffer_load_dwordx4 v[188:191], v1, s[8:11], s26 offen offset:512 nt
  s_waitcnt vmcnt(7)
  v_dot2_f32_bf16 v204, v164, s51, v196
  v_dot2_f32_bf16 v205, v164, s3, v197
  v_dot2_f32_bf16 v206, v165, s51, v198
  v_dot2_f32_bf16 v207, v165, s3, v199
  v_dot2_f32_bf16 v208, v166, s51, v200
  v_dot2_f32_bf16 v209, v166, s3, v201
  v_dot2_f32_bf16 v210, v167, s51, v202
  v_dot2_f32_bf16 v211, v167, s3, v203
  v_cvt_pk_bf16_f32 v164, v204, v205
  v_cvt_pk_bf16_f32 v165, v206, v207
  v_cvt_pk_bf16_f32 v166, v208, v209
  v_cvt_pk_bf16_f32 v167, v210, v211
  ds_write_b128 v4, v[164:167] offset:49408
  buffer_load_dwordx4 v[192:195], v1, s[8:11], s26 offen offset:1280 nt
  s_waitcnt vmcnt(7)
  v_dot2_f32_bf16 v204, v168, s51, v196
  v_dot2_f32_bf16 v205, v168, s3, v197
  v_dot2_f32_bf16 v206, v169, s51, v198
  v_dot2_f32_bf16 v207, v169, s3, v199
  v_dot2_f32_bf16 v208, v170, s51, v200
  v_dot2_f32_bf16 v209, v170, s3, v201
  v_dot2_f32_bf16 v210, v171, s51, v202
  v_dot2_f32_bf16 v211, v171, s3, v203
  v_cvt_pk_bf16_f32 v168, v204, v205
  v_cvt_pk_bf16_f32 v169, v206, v207
  v_cvt_pk_bf16_f32 v170, v208, v209
  v_cvt_pk_bf16_f32 v171, v210, v211
  ds_write_b128 v5, v[168:171] offset:50176
  s_add_u32 s96, s96, 1
  s_mul_i32 s27, s96, 976
  s_add_u32 s27, s27, s90
  s_cmp_gt_u32 s96, 8
  s_cselect_b32 s28, 4294966752, 0
  s_add_u32 s27, s27, s28
  s_cmp_eq_u32 s96, 8
  s_cselect_b32 s28, s91, 0
  s_cselect_b32 s23, s89, 0
  s_add_u32 s27, s27, s28
  s_mul_i32 s24, s27, 3072
  s_mul_hi_u32 s28, s27, 89478486
  s_mul_i32 s29, s28, 48
  s_sub_u32 s29, s27, s29
  s_mul_i32 s25, s28, 589824
  s_mul_i32 s29, s29, 6144
  s_add_u32 s25, s25, s29
  s_add_u32 s26, s25, 294912
  s_cmp_ge_u32 s96, 10
  s_cselect_b32 s23, 1, s23
  s_cmp_eq_u32 s23, 0
  s_cselect_b32 s10, 113246208, 0
  s_cselect_b32 s14, 28311552, 0
  buffer_load_dwordx4 v[76:79], v2, s[12:15], s24 offen offset:0 nt
  s_waitcnt vmcnt(7)
  v_dot2_f32_bf16 v204, v172, s51, v196
  v_dot2_f32_bf16 v205, v172, s3, v197
  v_dot2_f32_bf16 v206, v173, s51, v198
  v_dot2_f32_bf16 v207, v173, s3, v199
  v_dot2_f32_bf16 v208, v174, s51, v200
  v_dot2_f32_bf16 v209, v174, s3, v201
  v_dot2_f32_bf16 v210, v175, s51, v202
  v_dot2_f32_bf16 v211, v175, s3, v203
  v_cvt_pk_bf16_f32 v172, v204, v205
  v_cvt_pk_bf16_f32 v173, v206, v207
  v_cvt_pk_bf16_f32 v174, v208, v209
  v_cvt_pk_bf16_f32 v175, v210, v211
  ds_write_b128 v6, v[172:175] offset:50944
  buffer_load_dwordx4 v[88:91], v1, s[8:11], s25 offen offset:0 nt
  s_waitcnt vmcnt(7)
  v_dot2_f32_bf16 v204, v176, s51, v196
  v_dot2_f32_bf16 v205, v176, s3, v197
  v_dot2_f32_bf16 v206, v177, s51, v198
  v_dot2_f32_bf16 v207, v177, s3, v199
  v_dot2_f32_bf16 v208, v178, s51, v200
  v_dot2_f32_bf16 v209, v178, s3, v201
  v_dot2_f32_bf16 v210, v179, s51, v202
  v_dot2_f32_bf16 v211, v179, s3, v203
  v_cvt_pk_bf16_f32 v176, v204, v205
  v_cvt_pk_bf16_f32 v177, v206, v207
  v_cvt_pk_bf16_f32 v178, v208, v209
  v_cvt_pk_bf16_f32 v179, v210, v211
  ds_write_b128 v7, v[176:179] offset:51712
  buffer_load_dwordx4 v[92:95], v1, s[8:11], s25 offen offset:768 nt
  s_waitcnt vmcnt(7)
  v_lshlrev_b32 v196, 16, v144
  v_and_b32 v197, s44, v144
  v_lshlrev_b32 v198, 16, v145
  v_and_b32 v199, s44, v145
  v_lshlrev_b32 v200, 16, v146
  v_and_b32 v201, s44, v146
  v_lshlrev_b32 v202, 16, v147
  v_and_b32 v203, s44, v147
  buffer_load_dwordx4 v[96:99], v1, s[8:11], s26 offen offset:0 nt
  s_waitcnt vmcnt(7)
  v_dot2_f32_bf16 v204, v180, s51, v196
  v_dot2_f32_bf16 v205, v180, s3, v197
  v_dot2_f32_bf16 v206, v181, s51, v198
  v_dot2_f32_bf16 v207, v181, s3, v199
  v_dot2_f32_bf16 v208, v182, s51, v200
  v_dot2_f32_bf16 v209, v182, s3, v201
  v_dot2_f32_bf16 v210, v183, s51, v202
  v_dot2_f32_bf16 v211, v183, s3, v203
  v_cvt_pk_bf16_f32 v180, v204, v205
  v_cvt_pk_bf16_f32 v181, v206, v207
  v_cvt_pk_bf16_f32 v182, v208, v209
  v_cvt_pk_bf16_f32 v183, v210, v211
  ds_write_b128 v4, v[180:183] offset:49664
  buffer_load_dwordx4 v[100:103], v1, s[8:11], s26 offen offset:768 nt
  s_waitcnt vmcnt(7)
  v_dot2_f32_bf16 v204, v184, s51, v196
  v_dot2_f32_bf16 v205, v184, s3, v197
  v_dot2_f32_bf16 v206, v185, s51, v198
  v_dot2_f32_bf16 v207, v185, s3, v199
  v_dot2_f32_bf16 v208, v186, s51, v200
  v_dot2_f32_bf16 v209, v186, s3, v201
  v_dot2_f32_bf16 v210, v187, s51, v202
  v_dot2_f32_bf16 v211, v187, s3, v203
  v_cvt_pk_bf16_f32 v184, v204, v205
  v_cvt_pk_bf16_f32 v185, v206, v207
  v_cvt_pk_bf16_f32 v186, v208, v209
  v_cvt_pk_bf16_f32 v187, v210, v211
  ds_write_b128 v5, v[184:187] offset:50432
  buffer_load_dwordx4 v[80:83], v2, s[12:15], s24 offen offset:256 nt
  s_waitcnt vmcnt(7)
  v_dot2_f32_bf16 v204, v188, s51, v196
  v_dot2_f32_bf16 v205, v188, s3, v197
  v_dot2_f32_bf16 v206, v189, s51, v198
  v_dot2_f32_bf16 v207, v189, s3, v199
  v_dot2_f32_bf16 v208, v190, s51, v200
  v_dot2_f32_bf16 v209, v190, s3, v201
  v_dot2_f32_bf16 v210, v191, s51, v202
  v_dot2_f32_bf16 v211, v191, s3, v203
  v_cvt_pk_bf16_f32 v188, v204, v205
  v_cvt_pk_bf16_f32 v189, v206, v207
  v_cvt_pk_bf16_f32 v190, v208, v209
  v_cvt_pk_bf16_f32 v191, v210, v211
  ds_write_b128 v6, v[188:191] offset:51200
  buffer_load_dwordx4 v[104:107], v1, s[8:11], s25 offen offset:256 nt
  s_waitcnt vmcnt(7)
  v_dot2_f32_bf16 v204, v192, s51, v196
  v_dot2_f32_bf16 v205, v192, s3, v197
  v_dot2_f32_bf16 v206, v193, s51, v198
  v_dot2_f32_bf16 v207, v193, s3, v199
  v_dot2_f32_bf16 v208, v194, s51, v200
  v_dot2_f32_bf16 v209, v194, s3, v201
  v_dot2_f32_bf16 v210, v195, s51, v202
  v_dot2_f32_bf16 v211, v195, s3, v203
  v_cvt_pk_bf16_f32 v192, v204, v205
  v_cvt_pk_bf16_f32 v193, v206, v207
  v_cvt_pk_bf16_f32 v194, v208, v209
  v_cvt_pk_bf16_f32 v195, v210, v211
  ds_write_b128 v7, v[192:195] offset:51968
  ds_read_b128 a[48:51], v11 offset:49152
  ds_read_b128 a[52:55], v12 offset:49152
  ds_read_b128 a[56:59], v13 offset:49152
  ds_read_b128 a[60:63], v14 offset:49152
  ds_read_b128 a[64:67], v11 offset:49408
  ds_read_b128 a[68:71], v12 offset:49408
  ds_read_b128 a[72:75], v13 offset:49408
  ds_read_b128 a[76:79], v14 offset:49408
  ds_read_b128 a[80:83], v11 offset:49664
  ds_read_b128 a[84:87], v12 offset:49664
  ds_read_b128 a[88:91], v13 offset:49664
  ds_read_b128 a[92:95], v14 offset:49664
  s_waitcnt lgkmcnt(11)
  v_mfma_f32_16x16x32_bf16 v[60:63], a[48:51], a[48:51], 0
  v_mfma_f32_16x16x32_bf16 v[240:243], a[48:51], a[192:195], 0
  s_waitcnt lgkmcnt(10)
  v_mfma_f32_16x16x32_bf16 v[60:63], a[52:55], a[52:55], v[60:63]
  v_mfma_f32_16x16x32_bf16 v[240:243], a[52:55], a[192:195], v[240:243]
  s_waitcnt lgkmcnt(9)
  v_mfma_f32_16x16x32_bf16 v[60:63], a[56:59], a[56:59], v[60:63]
  v_mfma_f32_16x16x32_bf16 v[240:243], a[56:59], a[192:195], v[240:243]
  s_waitcnt lgkmcnt(8)
  v_mfma_f32_16x16x32_bf16 v[60:63], a[60:63], a[60:63], v[60:63]
  v_mfma_f32_16x16x32_bf16 v[240:243], a[60:63], a[192:195], v[240:243]
  s_waitcnt lgkmcnt(7)
  v_mfma_f32_16x16x32_bf16 v[60:63], a[64:67], a[64:67], v[60:63]
  v_mfma_f32_16x16x32_bf16 v[240:243], a[64:67], a[192:195], v[240:243]
  s_waitcnt lgkmcnt(6)
  v_mfma_f32_16x16x32_bf16 v[60:63], a[68:71], a[68:71], v[60:63]
  v_mfma_f32_16x16x32_bf16 v[240:243], a[68:71], a[192:195], v[240:243]
  s_waitcnt lgkmcnt(5)
  v_mfma_f32_16x16x32_bf16 v[60:63], a[72:75], a[72:75], v[60:63]
  v_mfma_f32_16x16x32_bf16 v[240:243], a[72:75], a[192:195], v[240:243]
  s_waitcnt lgkmcnt(4)
  v_mfma_f32_16x16x32_bf16 v[60:63], a[76:79], a[76:79], v[60:63]
  v_mfma_f32_16x16x32_bf16 v[240:243], a[76:79], a[192:195], v[240:243]
  s_waitcnt lgkmcnt(3)
  v_mfma_f32_16x16x32_bf16 v[60:63], a[80:83], a[80:83], v[60:63]
  v_mfma_f32_16x16x32_bf16 v[240:243], a[80:83], a[192:195], v[240:243]
  s_waitcnt lgkmcnt(2)
  v_mfma_f32_16x16x32_bf16 v[60:63], a[84:87], a[84:87], v[60:63]
  v_mfma_f32_16x16x32_bf16 v[240:243], a[84:87], a[192:195], v[240:243]
  s_waitcnt lgkmcnt(1)
  v_mfma_f32_16x16x32_bf16 v[60:63], a[88:91], a[88:91], v[60:63]
  v_mfma_f32_16x16x32_bf16 v[240:243], a[88:91], a[192:195], v[240:243]
  s_waitcnt lgkmcnt(0)
  v_mfma_f32_16x16x32_bf16 v[60:63], a[92:95], a[92:95], v[60:63]
  v_mfma_f32_16x16x32_bf16 v[240:243], a[92:95], a[192:195], v[240:243]
  s_nop 6
  v_cndmask_b32 v68, 0, v60, s[30:31]
  v_cndmask_b32 v68, v68, v61, s[32:33]
  v_cndmask_b32 v68, v68, v62, s[34:35]
  v_cndmask_b32 v68, v68, v63, s[36:37]
  v_cndmask_b32 v69, v240, v241, s[38:39]
  v_cndmask_b32 v69, v69, v242, s[40:41]
  v_add_f32_dpp v68, v68, v68 row_ror:4 row_mask:0xf bank_mask:0xf
  v_cndmask_b32 v69, v69, v243, s[42:43]
  v_mov_b32 v71, s46
  v_add_f32_dpp v68, v68, v68 row_ror:8 row_mask:0xf bank_mask:0xf
  v_mul_f32 v69, s45, v69
  v_fma_f32 v68, v68, s45, v71
  v_fma_f32 v68, -v69, v69, v68
  v_max_f32 v68, s46, v68
  v_rsq_f32 v248, v68
  buffer_load_dwordx4 v[108:111], v1, s[8:11], s25 offen offset:1024 nt
  s_waitcnt vmcnt(7)
  v_lshlrev_b32 v196, 16, v76
  v_and_b32 v197, s44, v76
  v_lshlrev_b32 v198, 16, v77
  v_and_b32 v199, s44, v77
  v_lshlrev_b32 v200, 16, v78
  v_and_b32 v201, s44, v78
  v_lshlrev_b32 v202, 16, v79
  v_and_b32 v203, s44, v79
  buffer_load_dwordx4 v[112:115], v1, s[8:11], s26 offen offset:256 nt
  s_waitcnt vmcnt(7)
  v_dot2_f32_bf16 v204, v88, s51, v196
  v_dot2_f32_bf16 v205, v88, s3, v197
  v_dot2_f32_bf16 v206, v89, s51, v198
  v_dot2_f32_bf16 v207, v89, s3, v199
  v_dot2_f32_bf16 v208, v90, s51, v200
  v_dot2_f32_bf16 v209, v90, s3, v201
  v_dot2_f32_bf16 v210, v91, s51, v202
  v_dot2_f32_bf16 v211, v91, s3, v203
  v_cvt_pk_bf16_f32 v88, v204, v205
  v_cvt_pk_bf16_f32 v89, v206, v207
  v_cvt_pk_bf16_f32 v90, v208, v209
  v_cvt_pk_bf16_f32 v91, v210, v211
  ds_write_b128 v236, v[88:91] offset:0
  buffer_load_dwordx4 v[116:119], v1, s[8:11], s26 offen offset:1024 nt
  s_waitcnt vmcnt(7)
  v_dot2_f32_bf16 v204, v92, s51, v196
  v_dot2_f32_bf16 v205, v92, s3, v197
  v_dot2_f32_bf16 v206, v93, s51, v198
  v_dot2_f32_bf16 v207, v93, s3, v199
  v_dot2_f32_bf16 v208, v94, s51, v200
  v_dot2_f32_bf16 v209, v94, s3, v201
  v_dot2_f32_bf16 v210, v95, s51, v202
  v_dot2_f32_bf16 v211, v95, s3, v203
  v_cvt_pk_bf16_f32 v92, v204, v205
  v_cvt_pk_bf16_f32 v93, v206, v207
  v_cvt_pk_bf16_f32 v94, v208, v209
  v_cvt_pk_bf16_f32 v95, v210, v211
  ds_write_b128 v237, v[92:95] offset:768
  buffer_load_dwordx4 v[84:87], v2, s[12:15], s24 offen offset:512 nt
  s_waitcnt vmcnt(7)
  v_dot2_f32_bf16 v204, v96, s51, v196
  v_dot2_f32_bf16 v205, v96, s3, v197
  v_dot2_f32_bf16 v206, v97, s51, v198
  v_dot2_f32_bf16 v207, v97, s3, v199
  v_dot2_f32_bf16 v208, v98, s51, v200
  v_dot2_f32_bf16 v209, v98, s3, v201
  v_dot2_f32_bf16 v210, v99, s51, v202
  v_dot2_f32_bf16 v211, v99, s3, v203
  v_cvt_pk_bf16_f32 v96, v204, v205
  v_cvt_pk_bf16_f32 v97, v206, v207
  v_cvt_pk_bf16_f32 v98, v208, v209
  v_cvt_pk_bf16_f32 v99, v210, v211
  ds_write_b128 v238, v[96:99] offset:1536
  buffer_load_dwordx4 v[120:123], v1, s[8:11], s25 offen offset:512 nt
  s_waitcnt vmcnt(7)
  v_dot2_f32_bf16 v204, v100, s51, v196
  v_dot2_f32_bf16 v205, v100, s3, v197
  v_dot2_f32_bf16 v206, v101, s51, v198
  v_dot2_f32_bf16 v207, v101, s3, v199
  v_dot2_f32_bf16 v208, v102, s51, v200
  v_dot2_f32_bf16 v209, v102, s3, v201
  v_dot2_f32_bf16 v210, v103, s51, v202
  v_dot2_f32_bf16 v211, v103, s3, v203
  v_cvt_pk_bf16_f32 v100, v204, v205
  v_cvt_pk_bf16_f32 v101, v206, v207
  v_cvt_pk_bf16_f32 v102, v208, v209
  v_cvt_pk_bf16_f32 v103, v210, v211
  ds_write_b128 v239, v[100:103] offset:2304
  buffer_load_dwordx4 v[124:127], v1, s[8:11], s25 offen offset:1280 nt
  s_waitcnt vmcnt(7)
  v_lshlrev_b32 v196, 16, v80
  v_and_b32 v197, s44, v80
  v_lshlrev_b32 v198, 16, v81
  v_and_b32 v199, s44, v81
  v_lshlrev_b32 v200, 16, v82
  v_and_b32 v201, s44, v82
  v_lshlrev_b32 v202, 16, v83
  v_and_b32 v203, s44, v83
  buffer_load_dwordx4 v[128:131], v1, s[8:11], s26 offen offset:512 nt
  s_waitcnt vmcnt(7)
  v_dot2_f32_bf16 v204, v104, s51, v196
  v_dot2_f32_bf16 v205, v104, s3, v197
  v_dot2_f32_bf16 v206, v105, s51, v198
  v_dot2_f32_bf16 v207, v105, s3, v199
  v_dot2_f32_bf16 v208, v106, s51, v200
  v_dot2_f32_bf16 v209, v106, s3, v201
  v_dot2_f32_bf16 v210, v107, s51, v202
  v_dot2_f32_bf16 v211, v107, s3, v203
  v_cvt_pk_bf16_f32 v104, v204, v205
  v_cvt_pk_bf16_f32 v105, v206, v207
  v_cvt_pk_bf16_f32 v106, v208, v209
  v_cvt_pk_bf16_f32 v107, v210, v211
  ds_write_b128 v236, v[104:107] offset:256
  buffer_load_dwordx4 v[132:135], v1, s[8:11], s26 offen offset:1280 nt
  s_waitcnt vmcnt(7)
  v_dot2_f32_bf16 v204, v108, s51, v196
  v_dot2_f32_bf16 v205, v108, s3, v197
  v_dot2_f32_bf16 v206, v109, s51, v198
  v_dot2_f32_bf16 v207, v109, s3, v199
  v_dot2_f32_bf16 v208, v110, s51, v200
  v_dot2_f32_bf16 v209, v110, s3, v201
  v_dot2_f32_bf16 v210, v111, s51, v202
  v_dot2_f32_bf16 v211, v111, s3, v203
  v_cvt_pk_bf16_f32 v108, v204, v205
  v_cvt_pk_bf16_f32 v109, v206, v207
  v_cvt_pk_bf16_f32 v110, v208, v209
  v_cvt_pk_bf16_f32 v111, v210, v211
  ds_write_b128 v237, v[108:111] offset:1024
  s_add_u32 s96, s96, 1
  s_mul_i32 s27, s96, 976
  s_add_u32 s27, s27, s90
  s_cmp_gt_u32 s96, 8
  s_cselect_b32 s28, 4294966752, 0
  s_add_u32 s27, s27, s28
  s_cmp_eq_u32 s96, 8
  s_cselect_b32 s28, s91, 0
  s_cselect_b32 s23, s89, 0
  s_add_u32 s27, s27, s28
  s_mul_i32 s24, s27, 3072
  s_mul_hi_u32 s28, s27, 89478486
  s_mul_i32 s29, s28, 48
  s_sub_u32 s29, s27, s29
  s_mul_i32 s25, s28, 589824
  s_mul_i32 s29, s29, 6144
  s_add_u32 s25, s25, s29
  s_add_u32 s26, s25, 294912
  s_cmp_ge_u32 s96, 10
  s_cselect_b32 s23, 1, s23
  s_cmp_eq_u32 s23, 0
  s_cselect_b32 s10, 113246208, 0
  s_cselect_b32 s14, 28311552, 0
  buffer_load_dwordx4 v[136:139], v2, s[12:15], s24 offen offset:0 nt
  s_waitcnt vmcnt(7)
  v_dot2_f32_bf16 v204, v112, s51, v196
  v_dot2_f32_bf16 v205, v112, s3, v197
  v_dot2_f32_bf16 v206, v113, s51, v198
  v_dot2_f32_bf16 v207, v113, s3, v199
  v_dot2_f32_bf16 v208, v114, s51, v200
  v_dot2_f32_bf16 v209, v114, s3, v201
  v_dot2_f32_bf16 v210, v115, s51, v202
  v_dot2_f32_bf16 v211, v115, s3, v203
  v_cvt_pk_bf16_f32 v112, v204, v205
  v_cvt_pk_bf16_f32 v113, v206, v207
  v_cvt_pk_bf16_f32 v114, v208, v209
  v_cvt_pk_bf16_f32 v115, v210, v211
  ds_write_b128 v238, v[112:115] offset:1792
  buffer_load_dwordx4 v[148:151], v1, s[8:11], s25 offen offset:0 nt
  s_waitcnt vmcnt(7)
  v_dot2_f32_bf16 v204, v116, s51, v196
  v_dot2_f32_bf16 v205, v116, s3, v197
  v_dot2_f32_bf16 v206, v117, s51, v198
  v_dot2_f32_bf16 v207, v117, s3, v199
  v_dot2_f32_bf16 v208, v118, s51, v200
  v_dot2_f32_bf16 v209, v118, s3, v201
  v_dot2_f32_bf16 v210, v119, s51, v202
  v_dot2_f32_bf16 v211, v119, s3, v203
  v_cvt_pk_bf16_f32 v116, v204, v205
  v_cvt_pk_bf16_f32 v117, v206, v207
  v_cvt_pk_bf16_f32 v118, v208, v209
  v_cvt_pk_bf16_f32 v119, v210, v211
  ds_write_b128 v239, v[116:119] offset:2560
  buffer_load_dwordx4 v[152:155], v1, s[8:11], s25 offen offset:768 nt
  s_waitcnt vmcnt(7)
  v_lshlrev_b32 v196, 16, v84
  v_and_b32 v197, s44, v84
  v_lshlrev_b32 v198, 16, v85
  v_and_b32 v199, s44, v85
  v_lshlrev_b32 v200, 16, v86
  v_and_b32 v201, s44, v86
  v_lshlrev_b32 v202, 16, v87
  v_and_b32 v203, s44, v87
  buffer_load_dwordx4 v[156:159], v1, s[8:11], s26 offen offset:0 nt
  s_waitcnt vmcnt(7)
  v_dot2_f32_bf16 v204, v120, s51, v196
  v_dot2_f32_bf16 v205, v120, s3, v197
  v_dot2_f32_bf16 v206, v121, s51, v198
  v_dot2_f32_bf16 v207, v121, s3, v199
  v_dot2_f32_bf16 v208, v122, s51, v200
  v_dot2_f32_bf16 v209, v122, s3, v201
  v_dot2_f32_bf16 v210, v123, s51, v202
  v_dot2_f32_bf16 v211, v123, s3, v203
  v_cvt_pk_bf16_f32 v120, v204, v205
  v_cvt_pk_bf16_f32 v121, v206, v207
  v_cvt_pk_bf16_f32 v122, v208, v209
  v_cvt_pk_bf16_f32 v123, v210, v211
  ds_write_b128 v236, v[120:123] offset:512
  buffer_load_dwordx4 v[160:163], v1, s[8:11], s26 offen offset:768 nt
  s_waitcnt vmcnt(7)
  v_dot2_f32_bf16 v204, v124, s51, v196
  v_dot2_f32_bf16 v205, v124, s3, v197
  v_dot2_f32_bf16 v206, v125, s51, v198
  v_dot2_f32_bf16 v207, v125, s3, v199
  v_dot2_f32_bf16 v208, v126, s51, v200
  v_dot2_f32_bf16 v209, v126, s3, v201
  v_dot2_f32_bf16 v210, v127, s51, v202
  v_dot2_f32_bf16 v211, v127, s3, v203
  v_cvt_pk_bf16_f32 v124, v204, v205
  v_cvt_pk_bf16_f32 v125, v206, v207
  v_cvt_pk_bf16_f32 v126, v208, v209
  v_cvt_pk_bf16_f32 v127, v210, v211
  ds_write_b128 v237, v[124:127] offset:1280
  buffer_load_dwordx4 v[140:143], v2, s[12:15], s24 offen offset:256 nt
  s_waitcnt vmcnt(7)
  v_dot2_f32_bf16 v204, v128, s51, v196
  v_dot2_f32_bf16 v205, v128, s3, v197
  v_dot2_f32_bf16 v206, v129, s51, v198
  v_dot2_f32_bf16 v207, v129, s3, v199
  v_dot2_f32_bf16 v208, v130, s51, v200
  v_dot2_f32_bf16 v209, v130, s3, v201
  v_dot2_f32_bf16 v210, v131, s51, v202
  v_dot2_f32_bf16 v211, v131, s3, v203
  v_cvt_pk_bf16_f32 v128, v204, v205
  v_cvt_pk_bf16_f32 v129, v206, v207
  v_cvt_pk_bf16_f32 v130, v208, v209
  v_cvt_pk_bf16_f32 v131, v210, v211
  ds_write_b128 v238, v[128:131] offset:2048
  buffer_load_dwordx4 v[164:167], v1, s[8:11], s25 offen offset:256 nt
  s_waitcnt vmcnt(7)
  v_dot2_f32_bf16 v204, v132, s51, v196
  v_dot2_f32_bf16 v205, v132, s3, v197
  v_dot2_f32_bf16 v206, v133, s51, v198
  v_dot2_f32_bf16 v207, v133, s3, v199
  v_dot2_f32_bf16 v208, v134, s51, v200
  v_dot2_f32_bf16 v209, v134, s3, v201
  v_dot2_f32_bf16 v210, v135, s51, v202
  v_dot2_f32_bf16 v211, v135, s3, v203
  v_cvt_pk_bf16_f32 v132, v204, v205
  v_cvt_pk_bf16_f32 v133, v206, v207
  v_cvt_pk_bf16_f32 v134, v208, v209
  v_cvt_pk_bf16_f32 v135, v210, v211
  ds_write_b128 v239, v[132:135] offset:2816
  s_mul_i32 s48, s20, 6144
  s_add_u32 s48, s48, 28672
  s_add_u32 s49, s48, 4096
  buffer_load_dwordx4 v[212:215], v3, s[16:19], s48 offen offset:0 sc1
  buffer_load_dwordx4 v[216:219], v3, s[16:19], s48 offen offset:1024 sc1
  buffer_load_dwordx4 v[220:223], v3, s[16:19], s48 offen offset:2048 sc1
  buffer_load_dwordx4 v[224:227], v3, s[16:19], s48 offen offset:3072 sc1
  buffer_load_dwordx4 v[228:231], v3, s[16:19], s49 offen offset:0 sc1
  buffer_load_dwordx4 v[232:235], v3, s[16:19], s49 offen offset:1024 sc1
  ds_read_b128 a[48:51], v29 offset:0
  ds_read_b128 a[52:55], v30 offset:0
  ds_read_b128 a[56:59], v31 offset:0
  ds_read_b128 a[60:63], v10 offset:0
  ds_read_b128 a[64:67], v29 offset:256
  ds_read_b128 a[68:71], v30 offset:256
  ds_read_b128 a[72:75], v31 offset:256
  ds_read_b128 a[76:79], v10 offset:256
  ds_read_b128 a[80:83], v29 offset:512
  ds_read_b128 a[84:87], v30 offset:512
  ds_read_b128 a[88:91], v31 offset:512
  ds_read_b128 a[92:95], v10 offset:512
  s_waitcnt lgkmcnt(11)
  v_mfma_f32_16x16x32_bf16 v[60:63], a[48:51], a[48:51], 0
  v_mfma_f32_16x16x32_bf16 v[244:247], a[48:51], a[192:195], 0
  s_waitcnt lgkmcnt(10)
  v_mfma_f32_16x16x32_bf16 v[60:63], a[52:55], a[52:55], v[60:63]
  v_mfma_f32_16x16x32_bf16 v[244:247], a[52:55], a[192:195], v[244:247]
  s_waitcnt lgkmcnt(9)
  v_mfma_f32_16x16x32_bf16 v[60:63], a[56:59], a[56:59], v[60:63]
  v_mfma_f32_16x16x32_bf16 v[244:247], a[56:59], a[192:195], v[244:247]
  s_waitcnt lgkmcnt(8)
  v_mfma_f32_16x16x32_bf16 v[60:63], a[60:63], a[60:63], v[60:63]
  v_mfma_f32_16x16x32_bf16 v[244:247], a[60:63], a[192:195], v[244:247]
  s_waitcnt lgkmcnt(7)
  v_mfma_f32_16x16x32_bf16 v[60:63], a[64:67], a[64:67], v[60:63]
  v_mfma_f32_16x16x32_bf16 v[244:247], a[64:67], a[192:195], v[244:247]
  s_waitcnt lgkmcnt(6)
  v_mfma_f32_16x16x32_bf16 v[60:63], a[68:71], a[68:71], v[60:63]
  v_mfma_f32_16x16x32_bf16 v[244:247], a[68:71], a[192:195], v[244:247]
  s_waitcnt lgkmcnt(5)
  v_mfma_f32_16x16x32_bf16 v[60:63], a[72:75], a[72:75], v[60:63]
  v_mfma_f32_16x16x32_bf16 v[244:247], a[72:75], a[192:195], v[244:247]
  s_waitcnt lgkmcnt(4)
  v_mfma_f32_16x16x32_bf16 v[60:63], a[76:79], a[76:79], v[60:63]
  v_mfma_f32_16x16x32_bf16 v[244:247], a[76:79], a[192:195], v[244:247]
  s_waitcnt lgkmcnt(3)
  v_mfma_f32_16x16x32_bf16 v[60:63], a[80:83], a[80:83], v[60:63]
  v_mfma_f32_16x16x32_bf16 v[244:247], a[80:83], a[192:195], v[244:247]
  s_waitcnt lgkmcnt(2)
  v_mfma_f32_16x16x32_bf16 v[60:63], a[84:87], a[84:87], v[60:63]
  v_mfma_f32_16x16x32_bf16 v[244:247], a[84:87], a[192:195], v[244:247]
  s_waitcnt lgkmcnt(1)
  v_mfma_f32_16x16x32_bf16 v[60:63], a[88:91], a[88:91], v[60:63]
  v_mfma_f32_16x16x32_bf16 v[244:247], a[88:91], a[192:195], v[244:247]
  s_waitcnt lgkmcnt(0)
  v_mfma_f32_16x16x32_bf16 v[60:63], a[92:95], a[92:95], v[60:63]
  v_mfma_f32_16x16x32_bf16 v[244:247], a[92:95], a[192:195], v[244:247]
  s_nop 6
  v_cndmask_b32 v68, 0, v60, s[30:31]
  v_cndmask_b32 v68, v68, v61, s[32:33]
  v_cndmask_b32 v68, v68, v62, s[34:35]
  v_cndmask_b32 v68, v68, v63, s[36:37]
  v_cndmask_b32 v69, v244, v245, s[38:39]
  v_cndmask_b32 v69, v69, v246, s[40:41]
  v_add_f32_dpp v68, v68, v68 row_ror:4 row_mask:0xf bank_mask:0xf
  v_cndmask_b32 v69, v69, v247, s[42:43]
  v_mov_b32 v71, s46
  v_add_f32_dpp v68, v68, v68 row_ror:8 row_mask:0xf bank_mask:0xf
  v_mul_f32 v69, s45, v69
  v_fma_f32 v68, v68, s45, v71
  v_fma_f32 v68, -v69, v69, v68
  v_max_f32 v68, s46, v68
  v_rsq_f32 v249, v68
  buffer_load_dwordx4 v[168:171], v1, s[8:11], s25 offen offset:1024 nt
  buffer_load_dwordx4 v[172:175], v1, s[8:11], s26 offen offset:256 nt
  buffer_load_dwordx4 v[176:179], v1, s[8:11], s26 offen offset:1024 nt
  buffer_load_dwordx4 v[144:147], v2, s[12:15], s24 offen offset:512 nt
  s_mul_i32 s48, s20, 6
  s_add_u32 s48, s48, 0
  s_lshr_b32 s49, s48, 2
  s_lshl_b32 s49, s49, 11
  s_and_b32 s48, s48, 3
  s_lshl_b32 s48, s48, 8
  s_add_u32 s48, s48, s49
  v_add_u32 v196, s48, v9
  s_mul_i32 s48, s20, 6
  s_add_u32 s48, s48, 1
  s_lshr_b32 s49, s48, 2
  s_lshl_b32 s49, s49, 11
  s_and_b32 s48, s48, 3
  s_lshl_b32 s48, s48, 8
  s_add_u32 s48, s48, s49
  v_add_u32 v197, s48, v9
  s_mul_i32 s48, s20, 6
  s_add_u32 s48, s48, 2
  s_lshr_b32 s49, s48, 2
  s_lshl_b32 s49, s49, 11
  s_and_b32 s48, s48, 3
  s_lshl_b32 s48, s48, 8
  s_add_u32 s48, s48, s49
  v_add_u32 v198, s48, v9
  s_mul_i32 s48, s20, 6
  s_add_u32 s48, s48, 3
  s_lshr_b32 s49, s48, 2
  s_lshl_b32 s49, s49, 11
  s_and_b32 s48, s48, 3
  s_lshl_b32 s48, s48, 8
  s_add_u32 s48, s48, s49
  v_add_u32 v199, s48, v9
  s_mul_i32 s48, s20, 6
  s_add_u32 s48, s48, 4
  s_lshr_b32 s49, s48, 2
  buffer_load_dwordx4 v[180:183], v1, s[8:11], s25 offen offset:512 nt
  s_lshl_b32 s49, s49, 11
  s_and_b32 s48, s48, 3
  s_lshl_b32 s48, s48, 8
  s_add_u32 s48, s48, s49
  v_add_u32 v200, s48, v9
  s_mul_i32 s48, s20, 6
  s_add_u32 s48, s48, 5
  s_lshr_b32 s49, s48, 2
  s_lshl_b32 s49, s49, 11
  s_and_b32 s48, s48, 3
  s_lshl_b32 s48, s48, 8
  s_add_u32 s48, s48, s49
  v_add_u32 v201, s48, v9
  v_add_u32 v202, 147968, v3
  ds_read_b128 a[96:99], v11 offset:0
  ds_read_b128 a[100:103], v12 offset:0
  ds_read_b128 a[104:107], v13 offset:0
  ds_read_b128 a[108:111], v14 offset:0
  ds_read_b128 a[112:115], v11 offset:256
  ds_read_b128 a[116:119], v12 offset:256
  ds_read_b128 a[120:123], v13 offset:256
  ds_read_b128 a[124:127], v14 offset:256
  ds_read_b128 a[128:131], v11 offset:512
  ds_read_b128 a[132:135], v12 offset:512
  ds_read_b128 a[136:139], v13 offset:512
  buffer_load_dwordx4 v[184:187], v1, s[8:11], s25 offen offset:1280 nt
  ds_read_b128 a[140:143], v14 offset:512
  ds_read_b128 a[144:147], v11 offset:49152
  ds_read_b128 a[148:151], v12 offset:49152
  ds_read_b128 a[152:155], v13 offset:49152
  ds_read_b128 a[156:159], v14 offset:49152
  ds_read_b128 a[160:163], v11 offset:49408
  ds_read_b128 a[164:167], v12 offset:49408
  ds_read_b128 a[168:171], v13 offset:49408
  ds_read_b128 a[172:175], v14 offset:49408
  ds_read_b128 a[176:179], v11 offset:49664
  ds_read_b128 a[180:183], v12 offset:49664
  ds_read_b128 a[184:187], v13 offset:49664
  ds_read_b128 a[188:191], v14 offset:49664
  s_waitcnt vmcnt(11)
  v_xor_b32 v212, v212, v8
  v_xor_b32 v213, v213, v8
  v_xor_b32 v214, v214, v8
  v_xor_b32 v215, v215, v8
  s_waitcnt vmcnt(10)
  v_xor_b32 v216, v216, v8
  v_xor_b32 v217, v217, v8
  v_xor_b32 v218, v218, v8
  v_xor_b32 v219, v219, v8
  s_waitcnt vmcnt(9)
  v_xor_b32 v220, v220, v8
  v_xor_b32 v221, v221, v8
  v_xor_b32 v222, v222, v8
  v_xor_b32 v223, v223, v8
  s_waitcnt vmcnt(8)
  v_xor_b32 v224, v224, v8
  v_xor_b32 v225, v225, v8
  v_xor_b32 v226, v226, v8
  v_xor_b32 v227, v227, v8
  s_waitcnt vmcnt(7)
  v_xor_b32 v228, v228, v8
  v_xor_b32 v229, v229, v8
  v_xor_b32 v230, v230, v8
  v_xor_b32 v231, v231, v8
  s_waitcnt vmcnt(6)
  v_xor_b32 v232, v232, v8
  v_xor_b32 v233, v233, v8
  v_xor_b32 v234, v234, v8
  v_xor_b32 v235, v235, v8
  v_or_b32 v71, v212, v213
  v_or3_b32 v71, v71, v214, v215
  v_or3_b32 v71, v71, v216, v217
  v_or3_b32 v71, v71, v218, v219
  v_or3_b32 v71, v71, v220, v221
  v_or3_b32 v71, v71, v222, v223
  v_or3_b32 v71, v71, v224, v225
  v_or3_b32 v71, v71, v226, v227
  v_or3_b32 v71, v71, v228, v229
  v_or3_b32 v71, v71, v230, v231
  v_or3_b32 v71, v71, v232, v233
  v_or3_b32 v71, v71, v234, v235
  v_and_b32 v71, s93, v71
  v_cmp_ne_u32 vcc, 0, v71
  s_cbranch_vccz standalone__detection_seg_dino__vision_kernel_pl1_ok
  s_mov_b32 s92, 0
standalone__detection_seg_dino__vision_kernel_pl1_retry:
  s_sleep 1
  s_mul_i32 s48, s20, 6144
  s_add_u32 s48, s48, 28672
  s_add_u32 s49, s48, 4096
  buffer_load_dwordx4 v[212:215], v3, s[16:19], s48 offen offset:0 sc1
  buffer_load_dwordx4 v[216:219], v3, s[16:19], s48 offen offset:1024 sc1
  buffer_load_dwordx4 v[220:223], v3, s[16:19], s48 offen offset:2048 sc1
  buffer_load_dwordx4 v[224:227], v3, s[16:19], s48 offen offset:3072 sc1
  buffer_load_dwordx4 v[228:231], v3, s[16:19], s49 offen offset:0 sc1
  buffer_load_dwordx4 v[232:235], v3, s[16:19], s49 offen offset:1024 sc1
  s_waitcnt vmcnt(0)
  v_xor_b32 v212, v212, v8
  v_xor_b32 v213, v213, v8
  v_xor_b32 v214, v214, v8
  v_xor_b32 v215, v215, v8
  v_xor_b32 v216, v216, v8
  v_xor_b32 v217, v217, v8
  v_xor_b32 v218, v218, v8
  v_xor_b32 v219, v219, v8
  v_xor_b32 v220, v220, v8
  v_xor_b32 v221, v221, v8
  v_xor_b32 v222, v222, v8
  v_xor_b32 v223, v223, v8
  v_xor_b32 v224, v224, v8
  v_xor_b32 v225, v225, v8
  v_xor_b32 v226, v226, v8
  v_xor_b32 v227, v227, v8
  v_xor_b32 v228, v228, v8
  v_xor_b32 v229, v229, v8
  v_xor_b32 v230, v230, v8
  v_xor_b32 v231, v231, v8
  v_xor_b32 v232, v232, v8
  v_xor_b32 v233, v233, v8
  v_xor_b32 v234, v234, v8
  v_xor_b32 v235, v235, v8
  v_or_b32 v71, v212, v213
  v_or3_b32 v71, v71, v214, v215
  v_or3_b32 v71, v71, v216, v217
  v_or3_b32 v71, v71, v218, v219
  v_or3_b32 v71, v71, v220, v221
  v_or3_b32 v71, v71, v222, v223
  v_or3_b32 v71, v71, v224, v225
  v_or3_b32 v71, v71, v226, v227
  v_or3_b32 v71, v71, v228, v229
  v_or3_b32 v71, v71, v230, v231
  v_or3_b32 v71, v71, v232, v233
  v_or3_b32 v71, v71, v234, v235
  v_and_b32 v71, s93, v71
  v_cmp_ne_u32 vcc, 0, v71
  s_waitcnt lgkmcnt(0)
  s_cbranch_vccz standalone__detection_seg_dino__vision_kernel_pl1_fin
  s_add_u32 s92, s92, 1
  s_cmp_lt_u32 s92, 1048576
  s_cbranch_scc1 standalone__detection_seg_dino__vision_kernel_pl1_retry
standalone__detection_seg_dino__vision_kernel_pl1_fin:
  s_nop 7
  s_nop 7
standalone__detection_seg_dino__vision_kernel_pl1_ok:
  v_cvt_pk_bf16_f32 v212, v212, v213
  buffer_load_dwordx4 v[188:191], v1, s[8:11], s26 offen offset:512 nt
  v_cvt_pk_bf16_f32 v213, v214, v215
  ds_write_b64 v196, v[212:213]
  v_cvt_pk_bf16_f32 v216, v216, v217
  v_cvt_pk_bf16_f32 v217, v218, v219
  ds_write_b64 v197, v[216:217]
  v_cvt_pk_bf16_f32 v220, v220, v221
  v_cvt_pk_bf16_f32 v221, v222, v223
  ds_write_b64 v198, v[220:221]
  v_cvt_pk_bf16_f32 v224, v224, v225
  v_cvt_pk_bf16_f32 v225, v226, v227
  ds_write_b64 v199, v[224:225]
  v_cvt_pk_bf16_f32 v228, v228, v229
  v_cvt_pk_bf16_f32 v229, v230, v231
  ds_write_b64 v200, v[228:229]
  v_cvt_pk_bf16_f32 v232, v232, v233
  v_cvt_pk_bf16_f32 v233, v234, v235
  ds_write_b64 v201, v[232:233]
  s_waitcnt lgkmcnt(0)
  s_barrier
  buffer_load_dwordx4 v[192:195], v1, s[8:11], s26 offen offset:1280 nt
  ds_read_b128 a[0:3], v202 offset:0
  ds_read_b128 a[4:7], v202 offset:1024
  ds_read_b128 a[8:11], v202 offset:2048
  ds_read_b128 a[12:15], v202 offset:3072
  ds_read_b128 a[16:19], v202 offset:4096
  ds_read_b128 a[20:23], v202 offset:5120
  ds_read_b128 a[24:27], v202 offset:6144
  ds_read_b128 a[28:31], v202 offset:7168
  ds_read_b128 a[32:35], v202 offset:8192
  ds_read_b128 a[36:39], v202 offset:9216
  ds_read_b128 a[40:43], v202 offset:10240
  ds_read_b128 a[44:47], v202 offset:11264
  s_waitcnt lgkmcnt(11)
  v_mfma_f32_16x16x32_bf16 v[60:63], a[192:195], a[0:3], 0
  v_mfma_f32_16x16x32_bf16 v[56:59], a[96:99], a[0:3], 0
  v_mfma_f32_16x16x32_bf16 v[212:215], a[144:147], a[0:3], 0
  s_add_u32 s96, s96, 1
  s_mul_i32 s27, s96, 976
  s_add_u32 s27, s27, s90
  s_cmp_gt_u32 s96, 8
  s_cselect_b32 s28, 4294966752, 0
  s_add_u32 s27, s27, s28
  s_cmp_eq_u32 s96, 8
  s_cselect_b32 s28, s91, 0
  s_cselect_b32 s23, s89, 0
  s_add_u32 s27, s27, s28
  s_mul_i32 s24, s27, 3072
  s_mul_hi_u32 s28, s27, 89478486
  s_mul_i32 s29, s28, 48
  s_sub_u32 s29, s27, s29
  s_mul_i32 s25, s28, 589824
  s_mul_i32 s29, s29, 6144
  s_add_u32 s25, s25, s29
  s_add_u32 s26, s25, 294912
  s_cmp_ge_u32 s96, 10
  s_cselect_b32 s23, 1, s23
  s_cmp_eq_u32 s23, 0
  s_cselect_b32 s10, 113246208, 0
  s_cselect_b32 s14, 28311552, 0
  buffer_load_dwordx4 v[76:79], v2, s[12:15], s24 offen offset:0 nt
  v_mfma_f32_16x16x32_bf16 v[216:219], a[48:51], a[0:3], 0
  s_waitcnt lgkmcnt(10)
  v_mfma_f32_16x16x32_bf16 v[60:63], a[192:195], a[4:7], v[60:63]
  v_mfma_f32_16x16x32_bf16 v[56:59], a[100:103], a[4:7], v[56:59]
  v_mfma_f32_16x16x32_bf16 v[212:215], a[148:151], a[4:7], v[212:215]
  v_mfma_f32_16x16x32_bf16 v[216:219], a[52:55], a[4:7], v[216:219]
  s_waitcnt lgkmcnt(9)
  v_mfma_f32_16x16x32_bf16 v[60:63], a[192:195], a[8:11], v[60:63]
  v_mfma_f32_16x16x32_bf16 v[56:59], a[104:107], a[8:11], v[56:59]
  v_mfma_f32_16x16x32_bf16 v[212:215], a[152:155], a[8:11], v[212:215]
  v_mfma_f32_16x16x32_bf16 v[216:219], a[56:59], a[8:11], v[216:219]
  buffer_load_dwordx4 v[88:91], v1, s[8:11], s25 offen offset:0 nt
  s_waitcnt lgkmcnt(8)
  v_mfma_f32_16x16x32_bf16 v[60:63], a[192:195], a[12:15], v[60:63]
  v_mfma_f32_16x16x32_bf16 v[56:59], a[108:111], a[12:15], v[56:59]
  v_mfma_f32_16x16x32_bf16 v[212:215], a[156:159], a[12:15], v[212:215]
  v_mfma_f32_16x16x32_bf16 v[216:219], a[60:63], a[12:15], v[216:219]
  s_waitcnt lgkmcnt(7)
  v_mfma_f32_16x16x32_bf16 v[60:63], a[192:195], a[16:19], v[60:63]
  v_mfma_f32_16x16x32_bf16 v[56:59], a[112:115], a[16:19], v[56:59]
  v_mfma_f32_16x16x32_bf16 v[212:215], a[160:163], a[16:19], v[212:215]
  v_mfma_f32_16x16x32_bf16 v[216:219], a[64:67], a[16:19], v[216:219]
  s_waitcnt lgkmcnt(6)
  v_mfma_f32_16x16x32_bf16 v[60:63], a[192:195], a[20:23], v[60:63]
  buffer_load_dwordx4 v[92:95], v1, s[8:11], s25 offen offset:768 nt
  v_mfma_f32_16x16x32_bf16 v[56:59], a[116:119], a[20:23], v[56:59]
  v_mfma_f32_16x16x32_bf16 v[212:215], a[164:167], a[20:23], v[212:215]
  v_mfma_f32_16x16x32_bf16 v[216:219], a[68:71], a[20:23], v[216:219]
  s_waitcnt lgkmcnt(5)
  v_mfma_f32_16x16x32_bf16 v[60:63], a[192:195], a[24:27], v[60:63]
  v_mfma_f32_16x16x32_bf16 v[56:59], a[120:123], a[24:27], v[56:59]
  v_mfma_f32_16x16x32_bf16 v[212:215], a[168:171], a[24:27], v[212:215]
  v_mfma_f32_16x16x32_bf16 v[216:219], a[72:75], a[24:27], v[216:219]
  s_waitcnt lgkmcnt(4)
  v_mfma_f32_16x16x32_bf16 v[60:63], a[192:195], a[28:31], v[60:63]
  v_mfma_f32_16x16x32_bf16 v[56:59], a[124:127], a[28:31], v[56:59]
  buffer_load_dwordx4 v[96:99], v1, s[8:11], s26 offen offset:0 nt
  v_mfma_f32_16x16x32_bf16 v[212:215], a[172:175], a[28:31], v[212:215]
  v_mfma_f32_16x16x32_bf16 v[216:219], a[76:79], a[28:31], v[216:219]
  s_waitcnt lgkmcnt(3)
  v_mfma_f32_16x16x32_bf16 v[60:63], a[192:195], a[32:35], v[60:63]
  v_mfma_f32_16x16x32_bf16 v[56:59], a[128:131], a[32:35], v[56:59]
  v_mfma_f32_16x16x32_bf16 v[212:215], a[176:179], a[32:35], v[212:215]
  v_mfma_f32_16x16x32_bf16 v[216:219], a[80:83], a[32:35], v[216:219]
  s_waitcnt lgkmcnt(2)
  v_mfma_f32_16x16x32_bf16 v[60:63], a[192:195], a[36:39], v[60:63]
  v_mfma_f32_16x16x32_bf16 v[56:59], a[132:135], a[36:39], v[56:59]
  v_mfma_f32_16x16x32_bf16 v[212:215], a[180:183], a[36:39], v[212:215]
  buffer_load_dwordx4 v[100:103], v1, s[8:11], s26 offen offset:768 nt
  v_mfma_f32_16x16x32_bf16 v[216:219], a[84:87], a[36:39], v[216:219]
  s_waitcnt lgkmcnt(1)
  v_mfma_f32_16x16x32_bf16 v[60:63], a[192:195], a[40:43], v[60:63]
  v_mfma_f32_16x16x32_bf16 v[56:59], a[136:139], a[40:43], v[56:59]
  v_mfma_f32_16x16x32_bf16 v[212:215], a[184:187], a[40:43], v[212:215]
  v_mfma_f32_16x16x32_bf16 v[216:219], a[88:91], a[40:43], v[216:219]
  s_waitcnt lgkmcnt(0)
  v_mfma_f32_16x16x32_bf16 v[60:63], a[192:195], a[44:47], v[60:63]
  v_mfma_f32_16x16x32_bf16 v[56:59], a[140:143], a[44:47], v[56:59]
  v_mfma_f32_16x16x32_bf16 v[212:215], a[188:191], a[44:47], v[212:215]
  v_mfma_f32_16x16x32_bf16 v[216:219], a[92:95], a[44:47], v[216:219]
  buffer_load_dwordx4 v[80:83], v2, s[12:15], s24 offen offset:256 nt
  s_nop 3
  v_mul_f32 v28, s45, v60
  v_fma_f32 v56, -v64, v28, v56
  v_fma_f32 v57, -v65, v28, v57
  v_fma_f32 v58, -v66, v28, v58
  v_fma_f32 v59, -v67, v28, v59
  v_mul_f32_dpp v56, v70, v56 quad_perm:[0,0,0,0] row_mask:0xf bank_mask:0xf
  v_mul_f32_dpp v57, v70, v57 quad_perm:[1,1,1,1] row_mask:0xf bank_mask:0xf
  v_mul_f32_dpp v58, v70, v58 quad_perm:[2,2,2,2] row_mask:0xf bank_mask:0xf
  v_mul_f32_dpp v59, v70, v59 quad_perm:[3,3,3,3] row_mask:0xf bank_mask:0xf
  v_fma_f32 v212, -v240, v28, v212
  v_fma_f32 v213, -v241, v28, v213
  v_fma_f32 v214, -v242, v28, v214
  v_fma_f32 v215, -v243, v28, v215
  v_mul_f32_dpp v212, v248, v212 quad_perm:[0,0,0,0] row_mask:0xf bank_mask:0xf
  v_mul_f32_dpp v213, v248, v213 quad_perm:[1,1,1,1] row_mask:0xf bank_mask:0xf
  v_mul_f32_dpp v214, v248, v214 quad_perm:[2,2,2,2] row_mask:0xf bank_mask:0xf
  v_mul_f32_dpp v215, v248, v215 quad_perm:[3,3,3,3] row_mask:0xf bank_mask:0xf
  v_fma_f32 v216, -v244, v28, v216
  v_fma_f32 v217, -v245, v28, v217
  v_fma_f32 v218, -v246, v28, v218
  v_fma_f32 v219, -v247, v28, v219
  v_mul_f32_dpp v216, v249, v216 quad_perm:[0,0,0,0] row_mask:0xf bank_mask:0xf
  v_mul_f32_dpp v217, v249, v217 quad_perm:[1,1,1,1] row_mask:0xf bank_mask:0xf
  v_mul_f32_dpp v218, v249, v218 quad_perm:[2,2,2,2] row_mask:0xf bank_mask:0xf
  v_mul_f32_dpp v219, v249, v219 quad_perm:[3,3,3,3] row_mask:0xf bank_mask:0xf
  v_max3_f32 v71, v56, v57, v58
  v_max3_f32 v71, v71, v59, v212
  v_max3_f32 v71, v71, v213, v214
  v_max3_f32 v71, v71, v215, v216
  v_max3_f32 v71, v71, v217, v218
  v_max_f32 v71, v71, v219
  v_mov_b32 v72, v71
  s_nop 1
  v_permlane32_swap_b32 v71, v72
  v_max_f32 v71, v71, v72
  v_mov_b32 v72, v71
  s_nop 1
  v_permlane16_swap_b32 v71, v72
  v_max_f32 v71, v71, v72
  buffer_load_dwordx4 v[104:107], v1, s[8:11], s25 offen offset:256 nt
  ds_write_b32 v21, v71
  s_waitcnt lgkmcnt(0)
  s_barrier
  ds_read_b128 v[60:63], v22
  ds_read_b64_tr_b16 a[96:97], v15 offset:0
  ds_read_b64_tr_b16 a[98:99], v15 offset:12288
  ds_read_b64_tr_b16 a[104:105], v16 offset:0
  ds_read_b64_tr_b16 a[106:107], v16 offset:12288
  ds_read_b64_tr_b16 a[112:113], v17 offset:0
  ds_read_b64_tr_b16 a[114:115], v17 offset:12288
  buffer_load_dwordx4 v[108:111], v1, s[8:11], s25 offen offset:1024 nt
  ds_read_b64_tr_b16 a[120:121], v18 offset:0
  ds_read_b64_tr_b16 a[122:123], v18 offset:12288
  ds_read_b64_tr_b16 a[128:129], v19 offset:0
  ds_read_b64_tr_b16 a[130:131], v19 offset:12288
  ds_read_b64_tr_b16 a[136:137], v20 offset:0
  ds_read_b64_tr_b16 a[138:139], v20 offset:12288
  s_waitcnt lgkmcnt(12)
  v_max3_f32 v71, v60, v61, v62
  v_max3_f32 v71, v71, v63, v25
  v_and_b32 v71, s87, v71
  v_sub_f32 v73, v25, v71
  v_mov_b32 v25, v71
  v_exp_f32 v73, v73
  v_sub_f32 v56, v56, v25
  v_sub_f32 v57, v57, v25
  v_sub_f32 v58, v58, v25
  v_sub_f32 v59, v59, v25
  v_sub_f32 v212, v212, v25
  v_sub_f32 v213, v213, v25
  v_sub_f32 v214, v214, v25
  v_sub_f32 v215, v215, v25
  v_sub_f32 v216, v216, v25
  v_sub_f32 v217, v217, v25
  v_sub_f32 v218, v218, v25
  v_sub_f32 v219, v219, v25
  v_exp_f32 v56, v56
  v_exp_f32 v57, v57
  buffer_load_dwordx4 v[112:115], v1, s[8:11], s26 offen offset:256 nt
  v_exp_f32 v58, v58
  v_exp_f32 v59, v59
  v_exp_f32 v212, v212
  v_exp_f32 v213, v213
  v_exp_f32 v214, v214
  v_exp_f32 v215, v215
  v_exp_f32 v216, v216
  v_exp_f32 v217, v217
  v_exp_f32 v218, v218
  v_exp_f32 v219, v219
  ds_read_b64_tr_b16 a[100:101], v15 offset:24576
  ds_read_b64_tr_b16 a[102:103], v15 offset:36864
  ds_read_b64_tr_b16 a[108:109], v16 offset:24576
  ds_read_b64_tr_b16 a[110:111], v16 offset:36864
  ds_read_b64_tr_b16 a[116:117], v17 offset:24576
  ds_read_b64_tr_b16 a[118:119], v17 offset:36864
  ds_read_b64_tr_b16 a[124:125], v18 offset:24576
  ds_read_b64_tr_b16 a[126:127], v18 offset:36864
  buffer_load_dwordx4 v[116:119], v1, s[8:11], s26 offen offset:1024 nt
  ds_read_b64_tr_b16 a[132:133], v19 offset:24576
  ds_read_b64_tr_b16 a[134:135], v19 offset:36864
  ds_read_b64_tr_b16 a[140:141], v20 offset:24576
  ds_read_b64_tr_b16 a[142:143], v20 offset:36864
  v_add_f32 v71, v56, v57
  v_add_f32 v72, v58, v59
  v_add_f32 v71, v71, v212
  v_add_f32 v72, v72, v213
  v_add_f32 v71, v71, v214
  v_add_f32 v72, v72, v215
  v_add_f32 v71, v71, v216
  v_add_f32 v72, v72, v217
  v_add_f32 v71, v71, v218
  v_add_f32 v72, v72, v219
  v_add_f32 v71, v71, v72
  v_fma_f32 v26, v26, v73, v71
  v_mul_f32_dpp v56, v70, v56 quad_perm:[0,0,0,0] row_mask:0xf bank_mask:0xf
  v_mul_f32_dpp v57, v70, v57 quad_perm:[1,1,1,1] row_mask:0xf bank_mask:0xf
  v_mul_f32_dpp v58, v70, v58 quad_perm:[2,2,2,2] row_mask:0xf bank_mask:0xf
  v_mul_f32_dpp v59, v70, v59 quad_perm:[3,3,3,3] row_mask:0xf bank_mask:0xf
  v_cvt_pk_bf16_f32 v74, v56, v57
  v_cvt_pk_bf16_f32 v75, v58, v59
  ds_write_b64 v23, v[74:75] offset:0
  v_mul_f32_dpp v212, v248, v212 quad_perm:[0,0,0,0] row_mask:0xf bank_mask:0xf
  v_mul_f32_dpp v213, v248, v213 quad_perm:[1,1,1,1] row_mask:0xf bank_mask:0xf
  v_mul_f32_dpp v214, v248, v214 quad_perm:[2,2,2,2] row_mask:0xf bank_mask:0xf
  v_mul_f32_dpp v215, v248, v215 quad_perm:[3,3,3,3] row_mask:0xf bank_mask:0xf
  v_cvt_pk_bf16_f32 v220, v212, v213
  v_cvt_pk_bf16_f32 v221, v214, v215
  ds_write_b64 v23, v[220:221] offset:2048
  buffer_load_dwordx4 v[84:87], v2, s[12:15], s24 offen offset:512 nt
  v_mul_f32_dpp v216, v249, v216 quad_perm:[0,0,0,0] row_mask:0xf bank_mask:0xf
  v_mul_f32_dpp v217, v249, v217 quad_perm:[1,1,1,1] row_mask:0xf bank_mask:0xf
  v_mul_f32_dpp v218, v249, v218 quad_perm:[2,2,2,2] row_mask:0xf bank_mask:0xf
  v_mul_f32_dpp v219, v249, v219 quad_perm:[3,3,3,3] row_mask:0xf bank_mask:0xf
  v_cvt_pk_bf16_f32 v222, v216, v217
  v_cvt_pk_bf16_f32 v223, v218, v219
  ds_write_b64 v23, v[222:223] offset:4096
  v_add_u32 v15, 49152, v15
  v_add_u32 v16, 49152, v16
  v_add_u32 v17, 49152, v17
  v_add_u32 v18, 49152, v18
  v_add_u32 v19, 49152, v19
  v_add_u32 v20, 49152, v20
  ds_read_b64_tr_b16 a[144:145], v15 offset:0
  ds_read_b64_tr_b16 a[146:147], v15 offset:12288
  ds_read_b64_tr_b16 a[152:153], v16 offset:0
  ds_read_b64_tr_b16 a[154:155], v16 offset:12288
  ds_read_b64_tr_b16 a[160:161], v17 offset:0
  ds_read_b64_tr_b16 a[162:163], v17 offset:12288
  ds_read_b64_tr_b16 a[168:169], v18 offset:0
  ds_read_b64_tr_b16 a[170:171], v18 offset:12288
  ds_read_b64_tr_b16 a[176:177], v19 offset:0
  ds_read_b64_tr_b16 a[178:179], v19 offset:12288
  ds_read_b64_tr_b16 a[184:185], v20 offset:0
  buffer_load_dwordx4 v[120:123], v1, s[8:11], s25 offen offset:512 nt
  ds_read_b64_tr_b16 a[186:187], v20 offset:12288
  ds_read_b64_tr_b16 a[148:149], v15 offset:24576
  ds_read_b64_tr_b16 a[150:151], v15 offset:36864
  ds_read_b64_tr_b16 a[156:157], v16 offset:24576
  ds_read_b64_tr_b16 a[158:159], v16 offset:36864
  ds_read_b64_tr_b16 a[164:165], v17 offset:24576
  ds_read_b64_tr_b16 a[166:167], v17 offset:36864
  ds_read_b64_tr_b16 a[172:173], v18 offset:24576
  ds_read_b64_tr_b16 a[174:175], v18 offset:36864
  ds_read_b64_tr_b16 a[180:181], v19 offset:24576
  ds_read_b64_tr_b16 a[182:183], v19 offset:36864
  ds_read_b64_tr_b16 a[188:189], v20 offset:24576
  ds_read_b64_tr_b16 a[190:191], v20 offset:36864
  v_mul_f32 v27, v27, v73
  v_fma_f32 v27, v56, v64, v27
  v_fma_f32 v27, v57, v65, v27
  v_fma_f32 v27, v58, v66, v27
  v_fma_f32 v27, v59, v67, v27
  v_fma_f32 v27, v212, v240, v27
  v_fma_f32 v27, v213, v241, v27
  v_fma_f32 v27, v214, v242, v27
  v_fma_f32 v27, v215, v243, v27
  buffer_load_dwordx4 v[124:127], v1, s[8:11], s25 offen offset:1280 nt
  v_fma_f32 v27, v216, v244, v27
  v_fma_f32 v27, v217, v245, v27
  v_fma_f32 v27, v218, v246, v27
  v_fma_f32 v27, v219, v247, v27
  s_waitcnt lgkmcnt(0)
  s_barrier
  ds_read_b128 v[56:59], v24 offset:0
  ds_read_b128 v[60:63], v24 offset:1024
  ds_read_b128 v[212:215], v24 offset:2048
  ds_read_b128 v[216:219], v24 offset:3072
  s_waitcnt lgkmcnt(3)
  v_mfma_f32_16x16x32_bf16 v[32:35], a[96:99], v[56:59], v[32:35]
  buffer_load_dwordx4 v[128:131], v1, s[8:11], s26 offen offset:512 nt
  v_mfma_f32_16x16x32_bf16 v[36:39], a[104:107], v[56:59], v[36:39]
  v_mfma_f32_16x16x32_bf16 v[40:43], a[112:115], v[56:59], v[40:43]
  v_mfma_f32_16x16x32_bf16 v[44:47], a[120:123], v[56:59], v[44:47]
  v_mfma_f32_16x16x32_bf16 v[48:51], a[128:131], v[56:59], v[48:51]
  v_mfma_f32_16x16x32_bf16 v[52:55], a[136:139], v[56:59], v[52:55]
  s_waitcnt lgkmcnt(2)
  v_mfma_f32_16x16x32_bf16 v[32:35], a[100:103], v[60:63], v[32:35]
  v_mfma_f32_16x16x32_bf16 v[36:39], a[108:111], v[60:63], v[36:39]
  v_mfma_f32_16x16x32_bf16 v[40:43], a[116:119], v[60:63], v[40:43]
  v_mfma_f32_16x16x32_bf16 v[44:47], a[124:127], v[60:63], v[44:47]
  buffer_load_dwordx4 v[132:135], v1, s[8:11], s26 offen offset:1280 nt
  v_mfma_f32_16x16x32_bf16 v[48:51], a[132:135], v[60:63], v[48:51]
  v_mfma_f32_16x16x32_bf16 v[52:55], a[140:143], v[60:63], v[52:55]
  v_add_u32 v15, 49152, v15
  v_add_u32 v16, 49152, v16
  v_add_u32 v17, 49152, v17
  v_add_u32 v18, 49152, v18
  v_add_u32 v19, 49152, v19
  v_add_u32 v20, 49152, v20
  ds_read_b64_tr_b16 a[96:97], v15 offset:0
  ds_read_b64_tr_b16 a[98:99], v15 offset:12288
  ds_read_b64_tr_b16 a[104:105], v16 offset:0
  ds_read_b64_tr_b16 a[106:107], v16 offset:12288
  ds_read_b64_tr_b16 a[112:113], v17 offset:0
  ds_read_b64_tr_b16 a[114:115], v17 offset:12288
  ds_read_b64_tr_b16 a[120:121], v18 offset:0
  ds_read_b64_tr_b16 a[122:123], v18 offset:12288
  ds_read_b64_tr_b16 a[128:129], v19 offset:0
  ds_read_b64_tr_b16 a[130:131], v19 offset:12288
  ds_read_b64_tr_b16 a[136:137], v20 offset:0
  ds_read_b64_tr_b16 a[138:139], v20 offset:12288
  ds_read_b64_tr_b16 a[100:101], v15 offset:24576
  ds_read_b64_tr_b16 a[102:103], v15 offset:36864
  ds_read_b64_tr_b16 a[108:109], v16 offset:24576
  ds_read_b64_tr_b16 a[110:111], v16 offset:36864
  ds_read_b64_tr_b16 a[116:117], v17 offset:24576
  ds_read_b64_tr_b16 a[118:119], v17 offset:36864
  ds_read_b64_tr_b16 a[124:125], v18 offset:24576
  ds_read_b64_tr_b16 a[126:127], v18 offset:36864
  ds_read_b64_tr_b16 a[132:133], v19 offset:24576
  ds_read_b64_tr_b16 a[134:135], v19 offset:36864
  ds_read_b64_tr_b16 a[140:141], v20 offset:24576
  ds_read_b64_tr_b16 a[142:143], v20 offset:36864
  ds_read_b128 v[56:59], v24 offset:4096
  ds_read_b128 v[60:63], v24 offset:5120
  v_mfma_f32_16x16x32_bf16 v[32:35], a[144:147], v[212:215], v[32:35]
  v_mfma_f32_16x16x32_bf16 v[36:39], a[152:155], v[212:215], v[36:39]
  v_mfma_f32_16x16x32_bf16 v[40:43], a[160:163], v[212:215], v[40:43]
  v_mfma_f32_16x16x32_bf16 v[44:47], a[168:171], v[212:215], v[44:47]
  v_mfma_f32_16x16x32_bf16 v[48:51], a[176:179], v[212:215], v[48:51]
  v_mfma_f32_16x16x32_bf16 v[52:55], a[184:187], v[212:215], v[52:55]
  v_mfma_f32_16x16x32_bf16 v[32:35], a[148:151], v[216:219], v[32:35]
  v_mfma_f32_16x16x32_bf16 v[36:39], a[156:159], v[216:219], v[36:39]
  v_mfma_f32_16x16x32_bf16 v[40:43], a[164:167], v[216:219], v[40:43]
  v_mfma_f32_16x16x32_bf16 v[44:47], a[172:175], v[216:219], v[44:47]
  v_mfma_f32_16x16x32_bf16 v[48:51], a[180:183], v[216:219], v[48:51]
  v_mfma_f32_16x16x32_bf16 v[52:55], a[188:191], v[216:219], v[52:55]
  s_waitcnt lgkmcnt(1)
  v_mfma_f32_16x16x32_bf16 v[32:35], a[96:99], v[56:59], v[32:35]
  v_mfma_f32_16x16x32_bf16 v[36:39], a[104:107], v[56:59], v[36:39]
  v_mfma_f32_16x16x32_bf16 v[40:43], a[112:115], v[56:59], v[40:43]
  v_mfma_f32_16x16x32_bf16 v[44:47], a[120:123], v[56:59], v[44:47]
  v_mfma_f32_16x16x32_bf16 v[48:51], a[128:131], v[56:59], v[48:51]
  v_mfma_f32_16x16x32_bf16 v[52:55], a[136:139], v[56:59], v[52:55]
  s_waitcnt lgkmcnt(0)
  v_mfma_f32_16x16x32_bf16 v[32:35], a[100:103], v[60:63], v[32:35]
  v_mfma_f32_16x16x32_bf16 v[36:39], a[108:111], v[60:63], v[36:39]
  v_mfma_f32_16x16x32_bf16 v[40:43], a[116:119], v[60:63], v[40:43]
  v_mfma_f32_16x16x32_bf16 v[44:47], a[124:127], v[60:63], v[44:47]
  v_mfma_f32_16x16x32_bf16 v[48:51], a[132:135], v[60:63], v[48:51]
  v_mfma_f32_16x16x32_bf16 v[52:55], a[140:143], v[60:63], v[52:55]
  s_lshl_b32 s48, s20, 2
  s_add_u32 s48, s48, 156160
  v_mov_b32 v250, s48
  v_mov_b32 v251, 156160
  s_mov_b32 s88, 0x41000000
  v_subrev_u32 v15, 98304, v15
  v_subrev_u32 v16, 98304, v16
  v_subrev_u32 v17, 98304, v17
  v_subrev_u32 v18, 98304, v18
  v_subrev_u32 v19, 98304, v19
  v_subrev_u32 v20, 98304, v20
  s_mov_b32 s47, 0
  s_mov_b32 s100, 2
  s_mov_b32 s101, 0
  s_add_u32 s100, s100, 1
  s_cmp_eq_u32 s100, 8
  s_cselect_b32 s22, s89, 0
  v_lshlrev_b32 v196, 16, v136
  v_and_b32 v197, s44, v136
  v_lshlrev_b32 v198, 16, v137
  v_and_b32 v199, s44, v137
  v_lshlrev_b32 v200, 16, v138
  v_and_b32 v201, s44, v138
  v_lshlrev_b32 v202, 16, v139
  v_and_b32 v203, s44, v139
  v_dot2_f32_bf16 v204, v148, s51, v196
  v_dot2_f32_bf16 v205, v148, s3, v197
  v_dot2_f32_bf16 v206, v149, s51, v198
  v_dot2_f32_bf16 v207, v149, s3, v199
  v_dot2_f32_bf16 v208, v150, s51, v200
  v_dot2_f32_bf16 v209, v150, s3, v201
  v_dot2_f32_bf16 v210, v151, s51, v202
  v_dot2_f32_bf16 v211, v151, s3, v203
  v_cvt_pk_bf16_f32 v148, v204, v205
  v_cvt_pk_bf16_f32 v149, v206, v207
  v_cvt_pk_bf16_f32 v150, v208, v209
  v_cvt_pk_bf16_f32 v151, v210, v211
  ds_write_b128 v4, v[148:151] offset:0
  v_dot2_f32_bf16 v204, v152, s51, v196
  v_dot2_f32_bf16 v205, v152, s3, v197
  v_dot2_f32_bf16 v206, v153, s51, v198
  v_dot2_f32_bf16 v207, v153, s3, v199
  v_dot2_f32_bf16 v208, v154, s51, v200
  v_dot2_f32_bf16 v209, v154, s3, v201
  v_dot2_f32_bf16 v210, v155, s51, v202
  v_dot2_f32_bf16 v211, v155, s3, v203
  v_cvt_pk_bf16_f32 v152, v204, v205
  v_cvt_pk_bf16_f32 v153, v206, v207
  v_cvt_pk_bf16_f32 v154, v208, v209
  v_cvt_pk_bf16_f32 v155, v210, v211
  ds_write_b128 v5, v[152:155] offset:768
  v_dot2_f32_bf16 v204, v156, s51, v196
  v_dot2_f32_bf16 v205, v156, s3, v197
  v_dot2_f32_bf16 v206, v157, s51, v198
  v_dot2_f32_bf16 v207, v157, s3, v199
  v_dot2_f32_bf16 v208, v158, s51, v200
  v_dot2_f32_bf16 v209, v158, s3, v201
  v_dot2_f32_bf16 v210, v159, s51, v202
  v_dot2_f32_bf16 v211, v159, s3, v203
  v_cvt_pk_bf16_f32 v156, v204, v205
  v_cvt_pk_bf16_f32 v157, v206, v207
  v_cvt_pk_bf16_f32 v158, v208, v209
  v_cvt_pk_bf16_f32 v159, v210, v211
  ds_write_b128 v6, v[156:159] offset:1536
  v_dot2_f32_bf16 v204, v160, s51, v196
  v_dot2_f32_bf16 v205, v160, s3, v197
  v_dot2_f32_bf16 v206, v161, s51, v198
  v_dot2_f32_bf16 v207, v161, s3, v199
  v_dot2_f32_bf16 v208, v162, s51, v200
  v_dot2_f32_bf16 v209, v162, s3, v201
  v_dot2_f32_bf16 v210, v163, s51, v202
  v_dot2_f32_bf16 v211, v163, s3, v203
  v_cvt_pk_bf16_f32 v160, v204, v205
  v_cvt_pk_bf16_f32 v161, v206, v207
  v_cvt_pk_bf16_f32 v162, v208, v209
  v_cvt_pk_bf16_f32 v163, v210, v211
  ds_write_b128 v7, v[160:163] offset:2304
  ds_read_b128 a[48:51], v11 offset:0
  ds_read_b128 a[52:55], v12 offset:0
  ds_read_b128 a[56:59], v13 offset:0
  ds_read_b128 a[60:63], v14 offset:0
  s_waitcnt vmcnt(22)
  v_lshlrev_b32 v196, 16, v140
  v_and_b32 v197, s44, v140
  v_lshlrev_b32 v198, 16, v141
  v_and_b32 v199, s44, v141
  v_lshlrev_b32 v200, 16, v142
  v_and_b32 v201, s44, v142
  v_lshlrev_b32 v202, 16, v143
  v_and_b32 v203, s44, v143
  v_dot2_f32_bf16 v204, v164, s51, v196
  v_dot2_f32_bf16 v205, v164, s3, v197
  v_dot2_f32_bf16 v206, v165, s51, v198
  v_dot2_f32_bf16 v207, v165, s3, v199
  v_dot2_f32_bf16 v208, v166, s51, v200
  v_dot2_f32_bf16 v209, v166, s3, v201
  v_dot2_f32_bf16 v210, v167, s51, v202
  v_dot2_f32_bf16 v211, v167, s3, v203
  v_cvt_pk_bf16_f32 v164, v204, v205
  v_cvt_pk_bf16_f32 v165, v206, v207
  v_cvt_pk_bf16_f32 v166, v208, v209
  s_waitcnt lgkmcnt(0)
  v_mfma_f32_16x16x32_bf16 v[60:63], a[48:51], a[48:51], 0
  v_cvt_pk_bf16_f32 v167, v210, v211
  ds_write_b128 v4, v[164:167] offset:256
  v_mfma_f32_16x16x32_bf16 v[64:67], a[48:51], a[192:195], 0
  v_dot2_f32_bf16 v204, v168, s51, v196
  v_dot2_f32_bf16 v205, v168, s3, v197
  v_mfma_f32_16x16x32_bf16 v[56:59], a[48:51], a[0:3], 0
  v_dot2_f32_bf16 v206, v169, s51, v198
  v_dot2_f32_bf16 v207, v169, s3, v199
  v_mfma_f32_16x16x32_bf16 v[60:63], a[52:55], a[52:55], v[60:63]
  v_dot2_f32_bf16 v208, v170, s51, v200
  v_dot2_f32_bf16 v209, v170, s3, v201
  v_mfma_f32_16x16x32_bf16 v[64:67], a[52:55], a[192:195], v[64:67]
  v_dot2_f32_bf16 v210, v171, s51, v202
  v_dot2_f32_bf16 v211, v171, s3, v203
  v_mfma_f32_16x16x32_bf16 v[56:59], a[52:55], a[4:7], v[56:59]
  v_cvt_pk_bf16_f32 v168, v204, v205
  v_cvt_pk_bf16_f32 v169, v206, v207
  v_mfma_f32_16x16x32_bf16 v[60:63], a[56:59], a[56:59], v[60:63]
  v_cvt_pk_bf16_f32 v170, v208, v209
  v_cvt_pk_bf16_f32 v171, v210, v211
  v_mfma_f32_16x16x32_bf16 v[64:67], a[56:59], a[192:195], v[64:67]
  ds_write_b128 v5, v[168:171] offset:1024
  s_waitcnt vmcnt(20)
  v_mfma_f32_16x16x32_bf16 v[56:59], a[56:59], a[8:11], v[56:59]
  v_dot2_f32_bf16 v204, v172, s51, v196
  v_dot2_f32_bf16 v205, v172, s3, v197
  v_mfma_f32_16x16x32_bf16 v[60:63], a[60:63], a[60:63], v[60:63]
  v_dot2_f32_bf16 v206, v173, s51, v198
  v_dot2_f32_bf16 v207, v173, s3, v199
  v_mfma_f32_16x16x32_bf16 v[64:67], a[60:63], a[192:195], v[64:67]
  v_dot2_f32_bf16 v208, v174, s51, v200
  v_dot2_f32_bf16 v209, v174, s3, v201
  v_mfma_f32_16x16x32_bf16 v[56:59], a[60:63], a[12:15], v[56:59]
  v_dot2_f32_bf16 v210, v175, s51, v202
  v_dot2_f32_bf16 v211, v175, s3, v203
  v_cvt_pk_bf16_f32 v172, v204, v205
  v_cvt_pk_bf16_f32 v173, v206, v207
  v_cvt_pk_bf16_f32 v174, v208, v209
  v_cvt_pk_bf16_f32 v175, v210, v211
  ds_write_b128 v6, v[172:175] offset:1792
  v_dot2_f32_bf16 v204, v176, s51, v196
  v_dot2_f32_bf16 v205, v176, s3, v197
  v_dot2_f32_bf16 v206, v177, s51, v198
  v_dot2_f32_bf16 v207, v177, s3, v199
  v_dot2_f32_bf16 v208, v178, s51, v200
  v_dot2_f32_bf16 v209, v178, s3, v201
  v_dot2_f32_bf16 v210, v179, s51, v202
  v_dot2_f32_bf16 v211, v179, s3, v203
  v_cvt_pk_bf16_f32 v176, v204, v205
  v_cvt_pk_bf16_f32 v177, v206, v207
  v_cvt_pk_bf16_f32 v178, v208, v209
  v_cvt_pk_bf16_f32 v179, v210, v211
  ds_write_b128 v7, v[176:179] offset:2560
  ds_read_b128 a[64:67], v11 offset:256
  ds_read_b128 a[68:71], v12 offset:256
  ds_read_b128 a[72:75], v13 offset:256
  ds_read_b128 a[76:79], v14 offset:256
  s_add_u32 s96, s96, 1
  s_mul_i32 s27, s96, 976
  s_add_u32 s27, s27, s90
  s_cmp_gt_u32 s96, 8
  s_cselect_b32 s28, 4294966752, 0
  s_add_u32 s27, s27, s28
  s_cmp_eq_u32 s96, 8
  s_cselect_b32 s28, s91, 0
  s_cselect_b32 s23, s89, 0
  s_add_u32 s27, s27, s28
  s_mul_i32 s24, s27, 3072
  s_mul_hi_u32 s28, s27, 89478486
  s_mul_i32 s29, s28, 48
  s_sub_u32 s29, s27, s29
  s_mul_i32 s25, s28, 589824
  s_mul_i32 s29, s29, 6144
  s_add_u32 s25, s25, s29
  s_add_u32 s26, s25, 294912
  s_cmp_ge_u32 s96, 10
  s_cselect_b32 s23, 1, s23
  s_cmp_eq_u32 s23, 0
  s_cselect_b32 s10, 113246208, 0
  s_cselect_b32 s14, 28311552, 0
  buffer_load_dwordx4 v[136:139], v2, s[12:15], s24 offen offset:0 nt
  s_waitcnt vmcnt(18)
  v_lshlrev_b32 v196, 16, v144
  v_and_b32 v197, s44, v144
  v_lshlrev_b32 v198, 16, v145
  v_and_b32 v199, s44, v145
  v_lshlrev_b32 v200, 16, v146
  v_and_b32 v201, s44, v146
  v_lshlrev_b32 v202, 16, v147
  v_and_b32 v203, s44, v147
  v_dot2_f32_bf16 v204, v180, s51, v196
  v_dot2_f32_bf16 v205, v180, s3, v197
  v_dot2_f32_bf16 v206, v181, s51, v198
  v_dot2_f32_bf16 v207, v181, s3, v199
  v_dot2_f32_bf16 v208, v182, s51, v200
  v_dot2_f32_bf16 v209, v182, s3, v201
  v_dot2_f32_bf16 v210, v183, s51, v202
  v_dot2_f32_bf16 v211, v183, s3, v203
  v_cvt_pk_bf16_f32 v180, v204, v205
  v_cvt_pk_bf16_f32 v181, v206, v207
  v_cvt_pk_bf16_f32 v182, v208, v209
  s_waitcnt lgkmcnt(0)
  v_mfma_f32_16x16x32_bf16 v[60:63], a[64:67], a[64:67], v[60:63]
  v_cvt_pk_bf16_f32 v183, v210, v211
  ds_write_b128 v4, v[180:183] offset:512
  v_mfma_f32_16x16x32_bf16 v[64:67], a[64:67], a[192:195], v[64:67]
  v_dot2_f32_bf16 v204, v184, s51, v196
  v_dot2_f32_bf16 v205, v184, s3, v197
  v_mfma_f32_16x16x32_bf16 v[56:59], a[64:67], a[16:19], v[56:59]
  buffer_load_dwordx4 v[148:151], v1, s[8:11], s25 offen offset:0 nt
  v_dot2_f32_bf16 v206, v185, s51, v198
  v_dot2_f32_bf16 v207, v185, s3, v199
  v_mfma_f32_16x16x32_bf16 v[60:63], a[68:71], a[68:71], v[60:63]
  v_dot2_f32_bf16 v208, v186, s51, v200
  v_dot2_f32_bf16 v209, v186, s3, v201
  v_mfma_f32_16x16x32_bf16 v[64:67], a[68:71], a[192:195], v[64:67]
  v_dot2_f32_bf16 v210, v187, s51, v202
  v_dot2_f32_bf16 v211, v187, s3, v203
  v_mfma_f32_16x16x32_bf16 v[56:59], a[68:71], a[20:23], v[56:59]
  v_cvt_pk_bf16_f32 v184, v204, v205
  v_cvt_pk_bf16_f32 v185, v206, v207
  v_mfma_f32_16x16x32_bf16 v[60:63], a[72:75], a[72:75], v[60:63]
  v_cvt_pk_bf16_f32 v186, v208, v209
  v_cvt_pk_bf16_f32 v187, v210, v211
  v_mfma_f32_16x16x32_bf16 v[64:67], a[72:75], a[192:195], v[64:67]
  ds_write_b128 v5, v[184:187] offset:1280
  s_waitcnt vmcnt(17)
  v_mfma_f32_16x16x32_bf16 v[56:59], a[72:75], a[24:27], v[56:59]
  v_dot2_f32_bf16 v204, v188, s51, v196
  v_dot2_f32_bf16 v205, v188, s3, v197
  v_mfma_f32_16x16x32_bf16 v[60:63], a[76:79], a[76:79], v[60:63]
  v_dot2_f32_bf16 v206, v189, s51, v198
  v_dot2_f32_bf16 v207, v189, s3, v199
  v_mfma_f32_16x16x32_bf16 v[64:67], a[76:79], a[192:195], v[64:67]
  buffer_load_dwordx4 v[152:155], v1, s[8:11], s25 offen offset:768 nt
  v_dot2_f32_bf16 v208, v190, s51, v200
  v_dot2_f32_bf16 v209, v190, s3, v201
  v_mfma_f32_16x16x32_bf16 v[56:59], a[76:79], a[28:31], v[56:59]
  v_dot2_f32_bf16 v210, v191, s51, v202
  v_dot2_f32_bf16 v211, v191, s3, v203
  v_cvt_pk_bf16_f32 v188, v204, v205
  v_cvt_pk_bf16_f32 v189, v206, v207
  v_cvt_pk_bf16_f32 v190, v208, v209
  v_cvt_pk_bf16_f32 v191, v210, v211
  ds_write_b128 v6, v[188:191] offset:2048
  v_dot2_f32_bf16 v204, v192, s51, v196
  v_dot2_f32_bf16 v205, v192, s3, v197
  v_dot2_f32_bf16 v206, v193, s51, v198
  v_dot2_f32_bf16 v207, v193, s3, v199
  v_dot2_f32_bf16 v208, v194, s51, v200
  v_dot2_f32_bf16 v209, v194, s3, v201
  v_dot2_f32_bf16 v210, v195, s51, v202
  v_dot2_f32_bf16 v211, v195, s3, v203
  v_cvt_pk_bf16_f32 v192, v204, v205
  v_cvt_pk_bf16_f32 v193, v206, v207
  v_cvt_pk_bf16_f32 v194, v208, v209
  v_cvt_pk_bf16_f32 v195, v210, v211
  ds_write_b128 v7, v[192:195] offset:2816
  ds_read_b128 a[80:83], v11 offset:512
  ds_read_b128 a[84:87], v12 offset:512
  ds_read_b128 a[88:91], v13 offset:512
  ds_read_b128 a[92:95], v14 offset:512
  buffer_load_dwordx4 v[156:159], v1, s[8:11], s26 offen offset:0 nt
  s_waitcnt lgkmcnt(0)
  s_barrier
  ds_read_b64_tr_b16 a[96:97], v15 offset:0
  ds_read_b64_tr_b16 a[98:99], v15 offset:12288
  v_mfma_f32_16x16x32_bf16 v[60:63], a[80:83], a[80:83], v[60:63]
  ds_read_b64_tr_b16 a[104:105], v16 offset:0
  ds_read_b64_tr_b16 a[106:107], v16 offset:12288
  v_mfma_f32_16x16x32_bf16 v[64:67], a[80:83], a[192:195], v[64:67]
  ds_read_b64_tr_b16 a[112:113], v17 offset:0
  ds_read_b64_tr_b16 a[114:115], v17 offset:12288
  v_mfma_f32_16x16x32_bf16 v[60:63], a[84:87], a[84:87], v[60:63]
  buffer_load_dwordx4 v[160:163], v1, s[8:11], s26 offen offset:768 nt
  ds_read_b64_tr_b16 a[120:121], v18 offset:0
  ds_read_b64_tr_b16 a[122:123], v18 offset:12288
  v_mfma_f32_16x16x32_bf16 v[64:67], a[84:87], a[192:195], v[64:67]
  ds_read_b64_tr_b16 a[128:129], v19 offset:0
  ds_read_b64_tr_b16 a[130:131], v19 offset:12288
  v_mfma_f32_16x16x32_bf16 v[60:63], a[88:91], a[88:91], v[60:63]
  ds_read_b64_tr_b16 a[136:137], v20 offset:0
  ds_read_b64_tr_b16 a[138:139], v20 offset:12288
  v_mfma_f32_16x16x32_bf16 v[64:67], a[88:91], a[192:195], v[64:67]
  ds_read_b64_tr_b16 a[100:101], v15 offset:24576
  ds_read_b64_tr_b16 a[102:103], v15 offset:36864
  v_mfma_f32_16x16x32_bf16 v[60:63], a[92:95], a[92:95], v[60:63]
  ds_read_b64_tr_b16 a[108:109], v16 offset:24576
  ds_read_b64_tr_b16 a[110:111], v16 offset:36864
  v_mfma_f32_16x16x32_bf16 v[64:67], a[92:95], a[192:195], v[64:67]
  ds_read_b64_tr_b16 a[116:117], v17 offset:24576
  ds_read_b64_tr_b16 a[118:119], v17 offset:36864
  v_mfma_f32_16x16x32_bf16 v[56:59], a[80:83], a[32:35], v[56:59]
  ds_read_b64_tr_b16 a[124:125], v18 offset:24576
  ds_read_b64_tr_b16 a[126:127], v18 offset:36864
  v_mfma_f32_16x16x32_bf16 v[56:59], a[84:87], a[36:39], v[56:59]
  ds_read_b64_tr_b16 a[132:133], v19 offset:24576
  ds_read_b64_tr_b16 a[134:135], v19 offset:36864
  v_mfma_f32_16x16x32_bf16 v[56:59], a[88:91], a[40:43], v[56:59]
  ds_read_b64_tr_b16 a[140:141], v20 offset:24576
  ds_read_b64_tr_b16 a[142:143], v20 offset:36864
  v_mfma_f32_16x16x32_bf16 v[56:59], a[92:95], a[44:47], v[56:59]
  v_cndmask_b32 v68, 0, v60, s[30:31]
  v_cndmask_b32 v68, v68, v61, s[32:33]
  v_cndmask_b32 v68, v68, v62, s[34:35]
  v_cndmask_b32 v68, v68, v63, s[36:37]
  v_cndmask_b32 v69, v64, v65, s[38:39]
  v_cndmask_b32 v69, v69, v66, s[40:41]
  v_add_f32_dpp v68, v68, v68 row_ror:4 row_mask:0xf bank_mask:0xf
  v_cndmask_b32 v69, v69, v67, s[42:43]
  v_mov_b32 v71, s46
  v_add_f32_dpp v68, v68, v68 row_ror:8 row_mask:0xf bank_mask:0xf
  v_mul_f32 v69, s45, v69
  v_fma_f32 v68, v68, s45, v71
  v_fma_f32 v68, -v69, v69, v68
  v_max_f32 v68, s46, v68
  v_rsq_f32 v70, v68
  v_fma_f32 v212, -v64, v28, v56
  v_fma_f32 v213, -v65, v28, v57
  v_fma_f32 v214, -v66, v28, v58
  v_fma_f32 v215, -v67, v28, v59
  v_sub_f32 v56, s22, v25
  v_mov_b32 v57, v56
  v_mov_b32 v58, v56
  v_mov_b32 v59, v56
  v_fmac_f32_dpp v56, v70, v212 quad_perm:[0,0,0,0] row_mask:0xf bank_mask:0xf
  v_fmac_f32_dpp v57, v70, v213 quad_perm:[1,1,1,1] row_mask:0xf bank_mask:0xf
  v_fmac_f32_dpp v58, v70, v214 quad_perm:[2,2,2,2] row_mask:0xf bank_mask:0xf
  v_fmac_f32_dpp v59, v70, v215 quad_perm:[3,3,3,3] row_mask:0xf bank_mask:0xf
  v_max3_f32 v71, v56, v57, v58
  v_max_f32 v71, v71, v59
  v_cmp_lt_f32 vcc, s88, v71
  v_exp_f32 v212, v56
  v_exp_f32 v213, v57
  v_exp_f32 v214, v58
  v_exp_f32 v215, v59
  s_cmp_lg_u64 vcc, 0
  s_cselect_b32 s48, 1, 0
  v_mov_b32 v72, s48
  v_add_f32 v216, v212, v213
  v_add_f32 v217, v214, v215
  ds_write_b32 v250, v72
  v_add_f32 v216, v216, v217
  v_mul_f32_dpp v212, v70, v212 quad_perm:[0,0,0,0] row_mask:0xf bank_mask:0xf
  v_mul_f32_dpp v213, v70, v213 quad_perm:[1,1,1,1] row_mask:0xf bank_mask:0xf
  v_mul_f32_dpp v214, v70, v214 quad_perm:[2,2,2,2] row_mask:0xf bank_mask:0xf
  v_mul_f32_dpp v215, v70, v215 quad_perm:[3,3,3,3] row_mask:0xf bank_mask:0xf
  v_cvt_pk_bf16_f32 v74, v212, v213
  v_cvt_pk_bf16_f32 v75, v214, v215
  ds_write_b64 v23, v[74:75]
  s_waitcnt lgkmcnt(0)
  s_barrier
  ds_read_b128 v[232:235], v251
  ds_read_b128 v[224:227], v24
  ds_read_b128 v[228:231], v24 offset:1024
  v_mul_f32 v217, v212, v64
  v_fma_f32 v217, v213, v65, v217
  v_fma_f32 v217, v214, v66, v217
  v_fma_f32 v217, v215, v67, v217
  s_waitcnt lgkmcnt(2)
  v_or3_b32 v71, v232, v233, v234
  v_or_b32 v71, v71, v235
  v_cmp_ne_u32 vcc, 0, v71
  s_cbranch_vccz standalone__detection_seg_dino__vision_kernel_lz2
  s_waitcnt lgkmcnt(0)
  v_max3_f32 v71, v56, v57, v58
  v_max_f32 v71, v71, v59
  v_mov_b32 v72, v71
  s_nop 1
  v_permlane32_swap_b32 v71, v72
  v_max_f32 v71, v71, v72
  v_mov_b32 v72, v71
  s_nop 1
  v_permlane16_swap_b32 v71, v72
  v_max_f32 v71, v71, v72
  ds_write_b32 v21, v71
  s_waitcnt lgkmcnt(0)
  s_barrier
  ds_read_b128 v[232:235], v22
  s_waitcnt lgkmcnt(0)
  v_max3_f32 v71, v232, v233, v234
  v_max3_f32 v71, v71, v235, 0
  v_add_f32 v72, v25, v71
  v_and_b32 v72, s87, v72
  v_sub_f32 v71, v72, v25
  v_mov_b32 v25, v72
  v_sub_f32 v73, 0, v71
  v_exp_f32 v73, v73
  v_sub_f32 v56, v56, v71
  v_sub_f32 v57, v57, v71
  v_sub_f32 v58, v58, v71
  v_sub_f32 v59, v59, v71
  v_mul_f32 v32, v32, v73
  v_mul_f32 v33, v33, v73
  v_mul_f32 v34, v34, v73
  v_mul_f32 v35, v35, v73
  v_mul_f32 v36, v36, v73
  v_mul_f32 v37, v37, v73
  v_mul_f32 v38, v38, v73
  v_mul_f32 v39, v39, v73
  v_mul_f32 v40, v40, v73
  v_mul_f32 v41, v41, v73
  v_mul_f32 v42, v42, v73
  v_mul_f32 v43, v43, v73
  v_mul_f32 v44, v44, v73
  v_mul_f32 v45, v45, v73
  v_mul_f32 v46, v46, v73
  v_mul_f32 v47, v47, v73
  v_mul_f32 v48, v48, v73
  v_mul_f32 v49, v49, v73
  v_mul_f32 v50, v50, v73
  v_mul_f32 v51, v51, v73
  v_mul_f32 v52, v52, v73
  v_mul_f32 v53, v53, v73
  v_mul_f32 v54, v54, v73
  v_mul_f32 v55, v55, v73
  v_mul_f32 v26, v26, v73
  v_mul_f32 v27, v27, v73
  v_exp_f32 v212, v56
  v_exp_f32 v213, v57
  v_exp_f32 v214, v58
  v_exp_f32 v215, v59
  v_add_f32 v216, v212, v213
  v_add_f32 v217, v214, v215
  v_add_f32 v216, v216, v217
  v_mul_f32_dpp v212, v70, v212 quad_perm:[0,0,0,0] row_mask:0xf bank_mask:0xf
  v_mul_f32_dpp v213, v70, v213 quad_perm:[1,1,1,1] row_mask:0xf bank_mask:0xf
  v_mul_f32_dpp v214, v70, v214 quad_perm:[2,2,2,2] row_mask:0xf bank_mask:0xf
  v_mul_f32_dpp v215, v70, v215 quad_perm:[3,3,3,3] row_mask:0xf bank_mask:0xf
  v_cvt_pk_bf16_f32 v74, v212, v213
  v_cvt_pk_bf16_f32 v75, v214, v215
  ds_write_b64 v23, v[74:75]
  v_mul_f32 v217, v212, v64
  v_fma_f32 v217, v213, v65, v217
  v_fma_f32 v217, v214, v66, v217
  v_fma_f32 v217, v215, v67, v217
  s_waitcnt lgkmcnt(0)
  s_barrier
  ds_read_b128 v[224:227], v24
  ds_read_b128 v[228:231], v24 offset:1024
  s_waitcnt lgkmcnt(0)
  s_nop 7
standalone__detection_seg_dino__vision_kernel_lz2:
  v_add_f32 v26, v26, v216
  v_add_f32 v27, v27, v217
standalone__detection_seg_dino__vision_kernel_zloop:
  s_add_u32 s47, s47, 1
  s_mov_b32 s48, 49152
  s_cmp_eq_u32 s47, 3
  s_cselect_b32 s48, 4294868992, s48
  s_cselect_b32 s47, 0, s47
  s_add_u32 s100, s100, 1
  s_cmp_eq_u32 s100, 8
  s_cselect_b32 s22, s89, 0
  v_add_u32 v4, s48, v4
  v_add_u32 v5, s48, v5
  v_add_u32 v6, s48, v6
  v_add_u32 v7, s48, v7
  v_add_u32 v11, s48, v11
  v_add_u32 v12, s48, v12
  v_add_u32 v13, s48, v13
  v_add_u32 v14, s48, v14
  v_add_u32 v15, s48, v15
  v_add_u32 v16, s48, v16
  v_add_u32 v17, s48, v17
  v_add_u32 v18, s48, v18
  v_add_u32 v19, s48, v19
  v_add_u32 v20, s48, v20
  buffer_load_dwordx4 v[140:143], v2, s[12:15], s24 offen offset:256 nt
  s_waitcnt vmcnt(18)
  v_lshlrev_b32 v196, 16, v76
  v_and_b32 v197, s44, v76
  v_lshlrev_b32 v198, 16, v77
  v_and_b32 v199, s44, v77
  v_lshlrev_b32 v200, 16, v78
  v_and_b32 v201, s44, v78
  v_lshlrev_b32 v202, 16, v79
  v_and_b32 v203, s44, v79
  v_dot2_f32_bf16 v204, v88, s51, v196
  v_dot2_f32_bf16 v205, v88, s3, v197
  v_dot2_f32_bf16 v206, v89, s51, v198
  v_dot2_f32_bf16 v207, v89, s3, v199
  v_dot2_f32_bf16 v208, v90, s51, v200
  v_dot2_f32_bf16 v209, v90, s3, v201
  v_dot2_f32_bf16 v210, v91, s51, v202
  s_waitcnt lgkmcnt(1)
  v_mfma_f32_16x16x32_bf16 v[32:35], a[96:99], v[224:227], v[32:35]
  v_dot2_f32_bf16 v211, v91, s3, v203
  v_cvt_pk_bf16_f32 v88, v204, v205
  v_mfma_f32_16x16x32_bf16 v[36:39], a[104:107], v[224:227], v[36:39]
  v_cvt_pk_bf16_f32 v89, v206, v207
  v_cvt_pk_bf16_f32 v90, v208, v209
  v_mfma_f32_16x16x32_bf16 v[40:43], a[112:115], v[224:227], v[40:43]
  v_cvt_pk_bf16_f32 v91, v210, v211
  ds_write_b128 v4, v[88:91] offset:0
  v_mfma_f32_16x16x32_bf16 v[44:47], a[120:123], v[224:227], v[44:47]
  buffer_load_dwordx4 v[164:167], v1, s[8:11], s25 offen offset:256 nt
  v_dot2_f32_bf16 v204, v92, s51, v196
  v_dot2_f32_bf16 v205, v92, s3, v197
  v_mfma_f32_16x16x32_bf16 v[48:51], a[128:131], v[224:227], v[48:51]
  v_dot2_f32_bf16 v206, v93, s51, v198
  v_dot2_f32_bf16 v207, v93, s3, v199
  v_mfma_f32_16x16x32_bf16 v[52:55], a[136:139], v[224:227], v[52:55]
  v_dot2_f32_bf16 v208, v94, s51, v200
  v_dot2_f32_bf16 v209, v94, s3, v201
  s_waitcnt lgkmcnt(1)
  v_mfma_f32_16x16x32_bf16 v[32:35], a[100:103], v[228:231], v[32:35]
  v_dot2_f32_bf16 v210, v95, s51, v202
  v_dot2_f32_bf16 v211, v95, s3, v203
  v_mfma_f32_16x16x32_bf16 v[36:39], a[108:111], v[228:231], v[36:39]
  v_cvt_pk_bf16_f32 v92, v204, v205
  v_cvt_pk_bf16_f32 v93, v206, v207
  v_mfma_f32_16x16x32_bf16 v[40:43], a[116:119], v[228:231], v[40:43]
  v_cvt_pk_bf16_f32 v94, v208, v209
  v_cvt_pk_bf16_f32 v95, v210, v211
  v_mfma_f32_16x16x32_bf16 v[44:47], a[124:127], v[228:231], v[44:47]
  ds_write_b128 v5, v[92:95] offset:768
  s_waitcnt vmcnt(17)
  v_mfma_f32_16x16x32_bf16 v[48:51], a[132:135], v[228:231], v[48:51]
  v_dot2_f32_bf16 v204, v96, s51, v196
  v_dot2_f32_bf16 v205, v96, s3, v197
  v_mfma_f32_16x16x32_bf16 v[52:55], a[140:143], v[228:231], v[52:55]
  buffer_load_dwordx4 v[168:171], v1, s[8:11], s25 offen offset:1024 nt
  v_dot2_f32_bf16 v206, v97, s51, v198
  v_dot2_f32_bf16 v207, v97, s3, v199
  v_dot2_f32_bf16 v208, v98, s51, v200
  v_dot2_f32_bf16 v209, v98, s3, v201
  v_dot2_f32_bf16 v210, v99, s51, v202
  v_dot2_f32_bf16 v211, v99, s3, v203
  v_cvt_pk_bf16_f32 v96, v204, v205
  v_cvt_pk_bf16_f32 v97, v206, v207
  v_cvt_pk_bf16_f32 v98, v208, v209
  v_cvt_pk_bf16_f32 v99, v210, v211
  ds_write_b128 v6, v[96:99] offset:1536
  v_dot2_f32_bf16 v204, v100, s51, v196
  v_dot2_f32_bf16 v205, v100, s3, v197
  v_dot2_f32_bf16 v206, v101, s51, v198
  v_dot2_f32_bf16 v207, v101, s3, v199
  v_dot2_f32_bf16 v208, v102, s51, v200
  v_dot2_f32_bf16 v209, v102, s3, v201
  v_dot2_f32_bf16 v210, v103, s51, v202
  v_dot2_f32_bf16 v211, v103, s3, v203
  v_cvt_pk_bf16_f32 v100, v204, v205
  v_cvt_pk_bf16_f32 v101, v206, v207
  v_cvt_pk_bf16_f32 v102, v208, v209
  v_cvt_pk_bf16_f32 v103, v210, v211
  ds_write_b128 v7, v[100:103] offset:2304
  ds_read_b128 a[48:51], v11 offset:0
  ds_read_b128 a[52:55], v12 offset:0
  ds_read_b128 a[56:59], v13 offset:0
  ds_read_b128 a[60:63], v14 offset:0
  buffer_load_dwordx4 v[172:175], v1, s[8:11], s26 offen offset:256 nt
  s_waitcnt vmcnt(16)
  v_lshlrev_b32 v196, 16, v80
  v_and_b32 v197, s44, v80
  v_lshlrev_b32 v198, 16, v81
  v_and_b32 v199, s44, v81
  v_lshlrev_b32 v200, 16, v82
  v_and_b32 v201, s44, v82
  v_lshlrev_b32 v202, 16, v83
  v_and_b32 v203, s44, v83
  v_dot2_f32_bf16 v204, v104, s51, v196
  v_dot2_f32_bf16 v205, v104, s3, v197
  v_dot2_f32_bf16 v206, v105, s51, v198
  v_dot2_f32_bf16 v207, v105, s3, v199
  v_dot2_f32_bf16 v208, v106, s51, v200
  v_dot2_f32_bf16 v209, v106, s3, v201
  v_dot2_f32_bf16 v210, v107, s51, v202
  v_dot2_f32_bf16 v211, v107, s3, v203
  v_cvt_pk_bf16_f32 v104, v204, v205
  v_cvt_pk_bf16_f32 v105, v206, v207
  v_cvt_pk_bf16_f32 v106, v208, v209
  s_waitcnt lgkmcnt(0)
  v_mfma_f32_16x16x32_bf16 v[60:63], a[48:51], a[48:51], 0
  v_cvt_pk_bf16_f32 v107, v210, v211
  ds_write_b128 v4, v[104:107] offset:256
  v_mfma_f32_16x16x32_bf16 v[64:67], a[48:51], a[192:195], 0
  v_dot2_f32_bf16 v204, v108, s51, v196
  v_dot2_f32_bf16 v205, v108, s3, v197
  v_mfma_f32_16x16x32_bf16 v[56:59], a[48:51], a[0:3], 0
  buffer_load_dwordx4 v[176:179], v1, s[8:11], s26 offen offset:1024 nt
  v_dot2_f32_bf16 v206, v109, s51, v198
  v_dot2_f32_bf16 v207, v109, s3, v199
  v_mfma_f32_16x16x32_bf16 v[60:63], a[52:55], a[52:55], v[60:63]
  v_dot2_f32_bf16 v208, v110, s51, v200
  v_dot2_f32_bf16 v209, v110, s3, v201
  v_mfma_f32_16x16x32_bf16 v[64:67], a[52:55], a[192:195], v[64:67]
  v_dot2_f32_bf16 v210, v111, s51, v202
  v_dot2_f32_bf16 v211, v111, s3, v203
  v_mfma_f32_16x16x32_bf16 v[56:59], a[52:55], a[4:7], v[56:59]
  v_cvt_pk_bf16_f32 v108, v204, v205
  v_cvt_pk_bf16_f32 v109, v206, v207
  v_mfma_f32_16x16x32_bf16 v[60:63], a[56:59], a[56:59], v[60:63]
  v_cvt_pk_bf16_f32 v110, v208, v209
  v_cvt_pk_bf16_f32 v111, v210, v211
  v_mfma_f32_16x16x32_bf16 v[64:67], a[56:59], a[192:195], v[64:67]
  ds_write_b128 v5, v[108:111] offset:1024
  s_waitcnt vmcnt(15)
  v_mfma_f32_16x16x32_bf16 v[56:59], a[56:59], a[8:11], v[56:59]
  v_dot2_f32_bf16 v204, v112, s51, v196
  v_dot2_f32_bf16 v205, v112, s3, v197
  v_mfma_f32_16x16x32_bf16 v[60:63], a[60:63], a[60:63], v[60:63]
  v_dot2_f32_bf16 v206, v113, s51, v198
  v_dot2_f32_bf16 v207, v113, s3, v199
  v_mfma_f32_16x16x32_bf16 v[64:67], a[60:63], a[192:195], v[64:67]
  buffer_load_dwordx4 v[144:147], v2, s[12:15], s24 offen offset:512 nt
  v_dot2_f32_bf16 v208, v114, s51, v200
  v_dot2_f32_bf16 v209, v114, s3, v201
  v_mfma_f32_16x16x32_bf16 v[56:59], a[60:63], a[12:15], v[56:59]
  v_dot2_f32_bf16 v210, v115, s51, v202
  v_dot2_f32_bf16 v211, v115, s3, v203
  v_cvt_pk_bf16_f32 v112, v204, v205
  v_cvt_pk_bf16_f32 v113, v206, v207
  v_cvt_pk_bf16_f32 v114, v208, v209
  v_cvt_pk_bf16_f32 v115, v210, v211
  ds_write_b128 v6, v[112:115] offset:1792
  v_dot2_f32_bf16 v204, v116, s51, v196
  v_dot2_f32_bf16 v205, v116, s3, v197
  v_dot2_f32_bf16 v206, v117, s51, v198
  v_dot2_f32_bf16 v207, v117, s3, v199
  v_dot2_f32_bf16 v208, v118, s51, v200
  v_dot2_f32_bf16 v209, v118, s3, v201
  v_dot2_f32_bf16 v210, v119, s51, v202
  v_dot2_f32_bf16 v211, v119, s3, v203
  v_cvt_pk_bf16_f32 v116, v204, v205
  v_cvt_pk_bf16_f32 v117, v206, v207
  v_cvt_pk_bf16_f32 v118, v208, v209
  v_cvt_pk_bf16_f32 v119, v210, v211
  ds_write_b128 v7, v[116:119] offset:2560
  ds_read_b128 a[64:67], v11 offset:256
  ds_read_b128 a[68:71], v12 offset:256
  ds_read_b128 a[72:75], v13 offset:256
  ds_read_b128 a[76:79], v14 offset:256
  buffer_load_dwordx4 v[180:183], v1, s[8:11], s25 offen offset:512 nt
  s_waitcnt vmcnt(14)
  v_lshlrev_b32 v196, 16, v84
  v_and_b32 v197, s44, v84
  v_lshlrev_b32 v198, 16, v85
  v_and_b32 v199, s44, v85
  v_lshlrev_b32 v200, 16, v86
  v_and_b32 v201, s44, v86
  v_lshlrev_b32 v202, 16, v87
  v_and_b32 v203, s44, v87
  v_dot2_f32_bf16 v204, v120, s51, v196
  v_dot2_f32_bf16 v205, v120, s3, v197
  v_dot2_f32_bf16 v206, v121, s51, v198
  v_dot2_f32_bf16 v207, v121, s3, v199
  v_dot2_f32_bf16 v208, v122, s51, v200
  v_dot2_f32_bf16 v209, v122, s3, v201
  v_dot2_f32_bf16 v210, v123, s51, v202
  v_dot2_f32_bf16 v211, v123, s3, v203
  v_cvt_pk_bf16_f32 v120, v204, v205
  v_cvt_pk_bf16_f32 v121, v206, v207
  v_cvt_pk_bf16_f32 v122, v208, v209
  s_waitcnt lgkmcnt(0)
  v_mfma_f32_16x16x32_bf16 v[60:63], a[64:67], a[64:67], v[60:63]
  v_cvt_pk_bf16_f32 v123, v210, v211
  ds_write_b128 v4, v[120:123] offset:512
  v_mfma_f32_16x16x32_bf16 v[64:67], a[64:67], a[192:195], v[64:67]
  v_dot2_f32_bf16 v204, v124, s51, v196
  v_dot2_f32_bf16 v205, v124, s3, v197
  v_mfma_f32_16x16x32_bf16 v[56:59], a[64:67], a[16:19], v[56:59]
  buffer_load_dwordx4 v[184:187], v1, s[8:11], s25 offen offset:1280 nt
  v_dot2_f32_bf16 v206, v125, s51, v198
  v_dot2_f32_bf16 v207, v125, s3, v199
  v_mfma_f32_16x16x32_bf16 v[60:63], a[68:71], a[68:71], v[60:63]
  v_dot2_f32_bf16 v208, v126, s51, v200
  v_dot2_f32_bf16 v209, v126, s3, v201
  v_mfma_f32_16x16x32_bf16 v[64:67], a[68:71], a[192:195], v[64:67]
  v_dot2_f32_bf16 v210, v127, s51, v202
  v_dot2_f32_bf16 v211, v127, s3, v203
  v_mfma_f32_16x16x32_bf16 v[56:59], a[68:71], a[20:23], v[56:59]
  v_cvt_pk_bf16_f32 v124, v204, v205
  v_cvt_pk_bf16_f32 v125, v206, v207
  v_mfma_f32_16x16x32_bf16 v[60:63], a[72:75], a[72:75], v[60:63]
  v_cvt_pk_bf16_f32 v126, v208, v209
  v_cvt_pk_bf16_f32 v127, v210, v211
  v_mfma_f32_16x16x32_bf16 v[64:67], a[72:75], a[192:195], v[64:67]
  ds_write_b128 v5, v[124:127] offset:1280
  s_waitcnt vmcnt(13)
  v_mfma_f32_16x16x32_bf16 v[56:59], a[72:75], a[24:27], v[56:59]
  v_dot2_f32_bf16 v204, v128, s51, v196
  v_dot2_f32_bf16 v205, v128, s3, v197
  v_mfma_f32_16x16x32_bf16 v[60:63], a[76:79], a[76:79], v[60:63]
  v_dot2_f32_bf16 v206, v129, s51, v198
  v_dot2_f32_bf16 v207, v129, s3, v199
  v_mfma_f32_16x16x32_bf16 v[64:67], a[76:79], a[192:195], v[64:67]
  buffer_load_dwordx4 v[188:191], v1, s[8:11], s26 offen offset:512 nt
  v_dot2_f32_bf16 v208, v130, s51, v200
  v_dot2_f32_bf16 v209, v130, s3, v201
  v_mfma_f32_16x16x32_bf16 v[56:59], a[76:79], a[28:31], v[56:59]
  v_dot2_f32_bf16 v210, v131, s51, v202
  v_dot2_f32_bf16 v211, v131, s3, v203
  v_cvt_pk_bf16_f32 v128, v204, v205
  v_cvt_pk_bf16_f32 v129, v206, v207
  v_cvt_pk_bf16_f32 v130, v208, v209
  v_cvt_pk_bf16_f32 v131, v210, v211
  ds_write_b128 v6, v[128:131] offset:2048
  v_dot2_f32_bf16 v204, v132, s51, v196
  v_dot2_f32_bf16 v205, v132, s3, v197
  v_dot2_f32_bf16 v206, v133, s51, v198
  v_dot2_f32_bf16 v207, v133, s3, v199
  v_dot2_f32_bf16 v208, v134, s51, v200
  v_dot2_f32_bf16 v209, v134, s3, v201
  v_dot2_f32_bf16 v210, v135, s51, v202
  v_dot2_f32_bf16 v211, v135, s3, v203
  v_cvt_pk_bf16_f32 v132, v204, v205
  v_cvt_pk_bf16_f32 v133, v206, v207
  v_cvt_pk_bf16_f32 v134, v208, v209
  v_cvt_pk_bf16_f32 v135, v210, v211
  ds_write_b128 v7, v[132:135] offset:2816
  ds_read_b128 a[80:83], v11 offset:512
  ds_read_b128 a[84:87], v12 offset:512
  ds_read_b128 a[88:91], v13 offset:512
  ds_read_b128 a[92:95], v14 offset:512
  buffer_load_dwordx4 v[192:195], v1, s[8:11], s26 offen offset:1280 nt
  s_waitcnt lgkmcnt(0)
  s_barrier
  ds_read_b64_tr_b16 a[96:97], v15 offset:0
  ds_read_b64_tr_b16 a[98:99], v15 offset:12288
  v_mfma_f32_16x16x32_bf16 v[60:63], a[80:83], a[80:83], v[60:63]
  ds_read_b64_tr_b16 a[104:105], v16 offset:0
  ds_read_b64_tr_b16 a[106:107], v16 offset:12288
  v_mfma_f32_16x16x32_bf16 v[64:67], a[80:83], a[192:195], v[64:67]
  ds_read_b64_tr_b16 a[112:113], v17 offset:0
  ds_read_b64_tr_b16 a[114:115], v17 offset:12288
  v_mfma_f32_16x16x32_bf16 v[60:63], a[84:87], a[84:87], v[60:63]
  s_add_u32 s96, s96, 1
  s_mul_i32 s27, s96, 976
  s_add_u32 s27, s27, s90
  s_cmp_gt_u32 s96, 8
  s_cselect_b32 s28, 4294966752, 0
  s_add_u32 s27, s27, s28
  s_cmp_eq_u32 s96, 8
  s_cselect_b32 s28, s91, 0
  s_cselect_b32 s23, s89, 0
  s_add_u32 s27, s27, s28
  s_mul_i32 s24, s27, 3072
  s_mul_hi_u32 s28, s27, 89478486
  s_mul_i32 s29, s28, 48
  s_sub_u32 s29, s27, s29
  s_mul_i32 s25, s28, 589824
  s_mul_i32 s29, s29, 6144
  s_add_u32 s25, s25, s29
  s_add_u32 s26, s25, 294912
  s_cmp_ge_u32 s96, 10
  s_cselect_b32 s23, 1, s23
  s_cmp_eq_u32 s23, 0
  s_cselect_b32 s10, 113246208, 0
  s_cselect_b32 s14, 28311552, 0
  buffer_load_dwordx4 v[76:79], v2, s[12:15], s24 offen offset:0 nt
  ds_read_b64_tr_b16 a[120:121], v18 offset:0
  ds_read_b64_tr_b16 a[122:123], v18 offset:12288
  v_mfma_f32_16x16x32_bf16 v[64:67], a[84:87], a[192:195], v[64:67]
  ds_read_b64_tr_b16 a[128:129], v19 offset:0
  ds_read_b64_tr_b16 a[130:131], v19 offset:12288
  v_mfma_f32_16x16x32_bf16 v[60:63], a[88:91], a[88:91], v[60:63]
  ds_read_b64_tr_b16 a[136:137], v20 offset:0
  ds_read_b64_tr_b16 a[138:139], v20 offset:12288
  v_mfma_f32_16x16x32_bf16 v[64:67], a[88:91], a[192:195], v[64:67]
  ds_read_b64_tr_b16 a[100:101], v15 offset:24576
  ds_read_b64_tr_b16 a[102:103], v15 offset:36864
  v_mfma_f32_16x16x32_bf16 v[60:63], a[92:95], a[92:95], v[60:63]
  ds_read_b64_tr_b16 a[108:109], v16 offset:24576
  ds_read_b64_tr_b16 a[110:111], v16 offset:36864
  v_mfma_f32_16x16x32_bf16 v[64:67], a[92:95], a[192:195], v[64:67]
  ds_read_b64_tr_b16 a[116:117], v17 offset:24576
  ds_read_b64_tr_b16 a[118:119], v17 offset:36864
  v_mfma_f32_16x16x32_bf16 v[56:59], a[80:83], a[32:35], v[56:59]
  ds_read_b64_tr_b16 a[124:125], v18 offset:24576
  ds_read_b64_tr_b16 a[126:127], v18 offset:36864
  v_mfma_f32_16x16x32_bf16 v[56:59], a[84:87], a[36:39], v[56:59]
  ds_read_b64_tr_b16 a[132:133], v19 offset:24576
  ds_read_b64_tr_b16 a[134:135], v19 offset:36864
  v_mfma_f32_16x16x32_bf16 v[56:59], a[88:91], a[40:43], v[56:59]
  ds_read_b64_tr_b16 a[140:141], v20 offset:24576
  ds_read_b64_tr_b16 a[142:143], v20 offset:36864
  v_mfma_f32_16x16x32_bf16 v[56:59], a[92:95], a[44:47], v[56:59]
  buffer_load_dwordx4 v[88:91], v1, s[8:11], s25 offen offset:0 nt
  v_cndmask_b32 v68, 0, v60, s[30:31]
  v_cndmask_b32 v68, v68, v61, s[32:33]
  v_cndmask_b32 v68, v68, v62, s[34:35]
  v_cndmask_b32 v68, v68, v63, s[36:37]
  v_cndmask_b32 v69, v64, v65, s[38:39]
  v_cndmask_b32 v69, v69, v66, s[40:41]
  v_add_f32_dpp v68, v68, v68 row_ror:4 row_mask:0xf bank_mask:0xf
  v_cndmask_b32 v69, v69, v67, s[42:43]
  v_mov_b32 v71, s46
  v_add_f32_dpp v68, v68, v68 row_ror:8 row_mask:0xf bank_mask:0xf
  v_mul_f32 v69, s45, v69
  v_fma_f32 v68, v68, s45, v71
  v_fma_f32 v68, -v69, v69, v68
  v_max_f32 v68, s46, v68
  v_rsq_f32 v70, v68
  v_fma_f32 v212, -v64, v28, v56
  v_fma_f32 v213, -v65, v28, v57
  v_fma_f32 v214, -v66, v28, v58
  v_fma_f32 v215, -v67, v28, v59
  v_sub_f32 v56, s22, v25
  v_mov_b32 v57, v56
  v_mov_b32 v58, v56
  v_mov_b32 v59, v56
  v_fmac_f32_dpp v56, v70, v212 quad_perm:[0,0,0,0] row_mask:0xf bank_mask:0xf
  v_fmac_f32_dpp v57, v70, v213 quad_perm:[1,1,1,1] row_mask:0xf bank_mask:0xf
  v_fmac_f32_dpp v58, v70, v214 quad_perm:[2,2,2,2] row_mask:0xf bank_mask:0xf
  v_fmac_f32_dpp v59, v70, v215 quad_perm:[3,3,3,3] row_mask:0xf bank_mask:0xf
  v_max3_f32 v71, v56, v57, v58
  v_max_f32 v71, v71, v59
  v_cmp_lt_f32 vcc, s88, v71
  v_exp_f32 v212, v56
  v_exp_f32 v213, v57
  v_exp_f32 v214, v58
  v_exp_f32 v215, v59
  s_cmp_lg_u64 vcc, 0
  s_cselect_b32 s48, 1, 0
  v_mov_b32 v72, s48
  buffer_load_dwordx4 v[92:95], v1, s[8:11], s25 offen offset:768 nt
  v_add_f32 v216, v212, v213
  v_add_f32 v217, v214, v215
  ds_write_b32 v250, v72
  v_add_f32 v216, v216, v217
  v_mul_f32_dpp v212, v70, v212 quad_perm:[0,0,0,0] row_mask:0xf bank_mask:0xf
  v_mul_f32_dpp v213, v70, v213 quad_perm:[1,1,1,1] row_mask:0xf bank_mask:0xf
  v_mul_f32_dpp v214, v70, v214 quad_perm:[2,2,2,2] row_mask:0xf bank_mask:0xf
  v_mul_f32_dpp v215, v70, v215 quad_perm:[3,3,3,3] row_mask:0xf bank_mask:0xf
  v_cvt_pk_bf16_f32 v74, v212, v213
  v_cvt_pk_bf16_f32 v75, v214, v215
  ds_write_b64 v23, v[74:75]
  s_waitcnt lgkmcnt(0)
  s_barrier
  ds_read_b128 v[232:235], v251
  buffer_load_dwordx4 v[96:99], v1, s[8:11], s26 offen offset:0 nt
  ds_read_b128 v[224:227], v24
  ds_read_b128 v[228:231], v24 offset:1024
  v_mul_f32 v217, v212, v64
  v_fma_f32 v217, v213, v65, v217
  v_fma_f32 v217, v214, v66, v217
  v_fma_f32 v217, v215, v67, v217
  s_waitcnt lgkmcnt(2)
  v_or3_b32 v71, v232, v233, v234
  v_or_b32 v71, v71, v235
  v_cmp_ne_u32 vcc, 0, v71
  s_cbranch_vccz standalone__detection_seg_dino__vision_kernel_lz3
  s_waitcnt lgkmcnt(0)
  v_max3_f32 v71, v56, v57, v58
  v_max_f32 v71, v71, v59
  v_mov_b32 v72, v71
  s_nop 1
  v_permlane32_swap_b32 v71, v72
  v_max_f32 v71, v71, v72
  v_mov_b32 v72, v71
  s_nop 1
  v_permlane16_swap_b32 v71, v72
  v_max_f32 v71, v71, v72
  ds_write_b32 v21, v71
  s_waitcnt lgkmcnt(0)
  s_barrier
  ds_read_b128 v[232:235], v22
  s_waitcnt lgkmcnt(0)
  v_max3_f32 v71, v232, v233, v234
  v_max3_f32 v71, v71, v235, 0
  v_add_f32 v72, v25, v71
  v_and_b32 v72, s87, v72
  v_sub_f32 v71, v72, v25
  v_mov_b32 v25, v72
  v_sub_f32 v73, 0, v71
  v_exp_f32 v73, v73
  v_sub_f32 v56, v56, v71
  v_sub_f32 v57, v57, v71
  v_sub_f32 v58, v58, v71
  v_sub_f32 v59, v59, v71
  v_mul_f32 v32, v32, v73
  v_mul_f32 v33, v33, v73
  v_mul_f32 v34, v34, v73
  v_mul_f32 v35, v35, v73
  v_mul_f32 v36, v36, v73
  v_mul_f32 v37, v37, v73
  v_mul_f32 v38, v38, v73
  v_mul_f32 v39, v39, v73
  v_mul_f32 v40, v40, v73
  v_mul_f32 v41, v41, v73
  v_mul_f32 v42, v42, v73
  v_mul_f32 v43, v43, v73
  v_mul_f32 v44, v44, v73
  v_mul_f32 v45, v45, v73
  v_mul_f32 v46, v46, v73
  v_mul_f32 v47, v47, v73
  v_mul_f32 v48, v48, v73
  v_mul_f32 v49, v49, v73
  v_mul_f32 v50, v50, v73
  v_mul_f32 v51, v51, v73
  v_mul_f32 v52, v52, v73
  v_mul_f32 v53, v53, v73
  v_mul_f32 v54, v54, v73
  v_mul_f32 v55, v55, v73
  v_mul_f32 v26, v26, v73
  v_mul_f32 v27, v27, v73
  v_exp_f32 v212, v56
  v_exp_f32 v213, v57
  v_exp_f32 v214, v58
  v_exp_f32 v215, v59
  v_add_f32 v216, v212, v213
  v_add_f32 v217, v214, v215
  v_add_f32 v216, v216, v217
  v_mul_f32_dpp v212, v70, v212 quad_perm:[0,0,0,0] row_mask:0xf bank_mask:0xf
  v_mul_f32_dpp v213, v70, v213 quad_perm:[1,1,1,1] row_mask:0xf bank_mask:0xf
  v_mul_f32_dpp v214, v70, v214 quad_perm:[2,2,2,2] row_mask:0xf bank_mask:0xf
  v_mul_f32_dpp v215, v70, v215 quad_perm:[3,3,3,3] row_mask:0xf bank_mask:0xf
  v_cvt_pk_bf16_f32 v74, v212, v213
  v_cvt_pk_bf16_f32 v75, v214, v215
  ds_write_b64 v23, v[74:75]
  v_mul_f32 v217, v212, v64
  v_fma_f32 v217, v213, v65, v217
  v_fma_f32 v217, v214, v66, v217
  v_fma_f32 v217, v215, v67, v217
  s_waitcnt lgkmcnt(0)
  s_barrier
  ds_read_b128 v[224:227], v24
  ds_read_b128 v[228:231], v24 offset:1024
  s_waitcnt lgkmcnt(0)
  s_nop 7
standalone__detection_seg_dino__vision_kernel_lz3:
  v_add_f32 v26, v26, v216
  buffer_load_dwordx4 v[100:103], v1, s[8:11], s26 offen offset:768 nt
  v_add_f32 v27, v27, v217
  s_add_u32 s47, s47, 1
  s_mov_b32 s48, 49152
  s_cmp_eq_u32 s47, 3
  s_cselect_b32 s48, 4294868992, s48
  s_cselect_b32 s47, 0, s47
  s_add_u32 s100, s100, 1
  s_cmp_eq_u32 s100, 8
  s_cselect_b32 s22, s89, 0
  v_add_u32 v4, s48, v4
  v_add_u32 v5, s48, v5
  v_add_u32 v6, s48, v6
  v_add_u32 v7, s48, v7
  v_add_u32 v11, s48, v11
  v_add_u32 v12, s48, v12
  v_add_u32 v13, s48, v13
  v_add_u32 v14, s48, v14
  v_add_u32 v15, s48, v15
  v_add_u32 v16, s48, v16
  v_add_u32 v17, s48, v17
  v_add_u32 v18, s48, v18
  v_add_u32 v19, s48, v19
  v_add_u32 v20, s48, v20
  buffer_load_dwordx4 v[80:83], v2, s[12:15], s24 offen offset:256 nt
  s_waitcnt vmcnt(18)
  v_lshlrev_b32 v196, 16, v136
  v_and_b32 v197, s44, v136
  v_lshlrev_b32 v198, 16, v137
  v_and_b32 v199, s44, v137
  v_lshlrev_b32 v200, 16, v138
  v_and_b32 v201, s44, v138
  v_lshlrev_b32 v202, 16, v139
  v_and_b32 v203, s44, v139
  v_dot2_f32_bf16 v204, v148, s51, v196
  v_dot2_f32_bf16 v205, v148, s3, v197
  v_dot2_f32_bf16 v206, v149, s51, v198
  v_dot2_f32_bf16 v207, v149, s3, v199
  v_dot2_f32_bf16 v208, v150, s51, v200
  v_dot2_f32_bf16 v209, v150, s3, v201
  v_dot2_f32_bf16 v210, v151, s51, v202
  s_waitcnt lgkmcnt(1)
  v_mfma_f32_16x16x32_bf16 v[32:35], a[96:99], v[224:227], v[32:35]
  v_dot2_f32_bf16 v211, v151, s3, v203
  v_cvt_pk_bf16_f32 v148, v204, v205
  v_mfma_f32_16x16x32_bf16 v[36:39], a[104:107], v[224:227], v[36:39]
  v_cvt_pk_bf16_f32 v149, v206, v207
  v_cvt_pk_bf16_f32 v150, v208, v209
  v_mfma_f32_16x16x32_bf16 v[40:43], a[112:115], v[224:227], v[40:43]
  v_cvt_pk_bf16_f32 v151, v210, v211
  ds_write_b128 v4, v[148:151] offset:0
  v_mfma_f32_16x16x32_bf16 v[44:47], a[120:123], v[224:227], v[44:47]
  buffer_load_dwordx4 v[104:107], v1, s[8:11], s25 offen offset:256 nt
  v_dot2_f32_bf16 v204, v152, s51, v196
  v_dot2_f32_bf16 v205, v152, s3, v197
  v_mfma_f32_16x16x32_bf16 v[48:51], a[128:131], v[224:227], v[48:51]
  v_dot2_f32_bf16 v206, v153, s51, v198
  v_dot2_f32_bf16 v207, v153, s3, v199
  v_mfma_f32_16x16x32_bf16 v[52:55], a[136:139], v[224:227], v[52:55]
  v_dot2_f32_bf16 v208, v154, s51, v200
  v_dot2_f32_bf16 v209, v154, s3, v201
  s_waitcnt lgkmcnt(1)
  v_mfma_f32_16x16x32_bf16 v[32:35], a[100:103], v[228:231], v[32:35]
  v_dot2_f32_bf16 v210, v155, s51, v202
  v_dot2_f32_bf16 v211, v155, s3, v203
  v_mfma_f32_16x16x32_bf16 v[36:39], a[108:111], v[228:231], v[36:39]
  v_cvt_pk_bf16_f32 v152, v204, v205
  v_cvt_pk_bf16_f32 v153, v206, v207
  v_mfma_f32_16x16x32_bf16 v[40:43], a[116:119], v[228:231], v[40:43]
  v_cvt_pk_bf16_f32 v154, v208, v209
  v_cvt_pk_bf16_f32 v155, v210, v211
  v_mfma_f32_16x16x32_bf16 v[44:47], a[124:127], v[228:231], v[44:47]
  ds_write_b128 v5, v[152:155] offset:768
  s_waitcnt vmcnt(17)
  v_mfma_f32_16x16x32_bf16 v[48:51], a[132:135], v[228:231], v[48:51]
  v_dot2_f32_bf16 v204, v156, s51, v196
  v_dot2_f32_bf16 v205, v156, s3, v197
  v_mfma_f32_16x16x32_bf16 v[52:55], a[140:143], v[228:231], v[52:55]
  buffer_load_dwordx4 v[108:111], v1, s[8:11], s25 offen offset:1024 nt
  v_dot2_f32_bf16 v206, v157, s51, v198
  v_dot2_f32_bf16 v207, v157, s3, v199
  v_dot2_f32_bf16 v208, v158, s51, v200
  v_dot2_f32_bf16 v209, v158, s3, v201
  v_dot2_f32_bf16 v210, v159, s51, v202
  v_dot2_f32_bf16 v211, v159, s3, v203
  v_cvt_pk_bf16_f32 v156, v204, v205
  v_cvt_pk_bf16_f32 v157, v206, v207
  v_cvt_pk_bf16_f32 v158, v208, v209
  v_cvt_pk_bf16_f32 v159, v210, v211
  ds_write_b128 v6, v[156:159] offset:1536
  v_dot2_f32_bf16 v204, v160, s51, v196
  v_dot2_f32_bf16 v205, v160, s3, v197
  v_dot2_f32_bf16 v206, v161, s51, v198
  v_dot2_f32_bf16 v207, v161, s3, v199
  v_dot2_f32_bf16 v208, v162, s51, v200
  v_dot2_f32_bf16 v209, v162, s3, v201
  v_dot2_f32_bf16 v210, v163, s51, v202
  v_dot2_f32_bf16 v211, v163, s3, v203
  v_cvt_pk_bf16_f32 v160, v204, v205
  v_cvt_pk_bf16_f32 v161, v206, v207
  v_cvt_pk_bf16_f32 v162, v208, v209
  v_cvt_pk_bf16_f32 v163, v210, v211
  ds_write_b128 v7, v[160:163] offset:2304
  ds_read_b128 a[48:51], v11 offset:0
  ds_read_b128 a[52:55], v12 offset:0
  ds_read_b128 a[56:59], v13 offset:0
  ds_read_b128 a[60:63], v14 offset:0
  buffer_load_dwordx4 v[112:115], v1, s[8:11], s26 offen offset:256 nt
  s_waitcnt vmcnt(16)
  v_lshlrev_b32 v196, 16, v140
  v_and_b32 v197, s44, v140
  v_lshlrev_b32 v198, 16, v141
  v_and_b32 v199, s44, v141
  v_lshlrev_b32 v200, 16, v142
  v_and_b32 v201, s44, v142
  v_lshlrev_b32 v202, 16, v143
  v_and_b32 v203, s44, v143
  v_dot2_f32_bf16 v204, v164, s51, v196
  v_dot2_f32_bf16 v205, v164, s3, v197
  v_dot2_f32_bf16 v206, v165, s51, v198
  v_dot2_f32_bf16 v207, v165, s3, v199
  v_dot2_f32_bf16 v208, v166, s51, v200
  v_dot2_f32_bf16 v209, v166, s3, v201
  v_dot2_f32_bf16 v210, v167, s51, v202
  v_dot2_f32_bf16 v211, v167, s3, v203
  v_cvt_pk_bf16_f32 v164, v204, v205
  v_cvt_pk_bf16_f32 v165, v206, v207
  v_cvt_pk_bf16_f32 v166, v208, v209
  s_waitcnt lgkmcnt(0)
  v_mfma_f32_16x16x32_bf16 v[60:63], a[48:51], a[48:51], 0
  v_cvt_pk_bf16_f32 v167, v210, v211
  ds_write_b128 v4, v[164:167] offset:256
  v_mfma_f32_16x16x32_bf16 v[64:67], a[48:51], a[192:195], 0
  v_dot2_f32_bf16 v204, v168, s51, v196
  v_dot2_f32_bf16 v205, v168, s3, v197
  v_mfma_f32_16x16x32_bf16 v[56:59], a[48:51], a[0:3], 0
  buffer_load_dwordx4 v[116:119], v1, s[8:11], s26 offen offset:1024 nt
  v_dot2_f32_bf16 v206, v169, s51, v198
  v_dot2_f32_bf16 v207, v169, s3, v199
  v_mfma_f32_16x16x32_bf16 v[60:63], a[52:55], a[52:55], v[60:63]
  v_dot2_f32_bf16 v208, v170, s51, v200
  v_dot2_f32_bf16 v209, v170, s3, v201
  v_mfma_f32_16x16x32_bf16 v[64:67], a[52:55], a[192:195], v[64:67]
  v_dot2_f32_bf16 v210, v171, s51, v202
  v_dot2_f32_bf16 v211, v171, s3, v203
  v_mfma_f32_16x16x32_bf16 v[56:59], a[52:55], a[4:7], v[56:59]
  v_cvt_pk_bf16_f32 v168, v204, v205
  v_cvt_pk_bf16_f32 v169, v206, v207
  v_mfma_f32_16x16x32_bf16 v[60:63], a[56:59], a[56:59], v[60:63]
  v_cvt_pk_bf16_f32 v170, v208, v209
  v_cvt_pk_bf16_f32 v171, v210, v211
  v_mfma_f32_16x16x32_bf16 v[64:67], a[56:59], a[192:195], v[64:67]
  ds_write_b128 v5, v[168:171] offset:1024
  s_waitcnt vmcnt(15)
  v_mfma_f32_16x16x32_bf16 v[56:59], a[56:59], a[8:11], v[56:59]
  v_dot2_f32_bf16 v204, v172, s51, v196
  v_dot2_f32_bf16 v205, v172, s3, v197
  v_mfma_f32_16x16x32_bf16 v[60:63], a[60:63], a[60:63], v[60:63]
  v_dot2_f32_bf16 v206, v173, s51, v198
  v_dot2_f32_bf16 v207, v173, s3, v199
  v_mfma_f32_16x16x32_bf16 v[64:67], a[60:63], a[192:195], v[64:67]
  buffer_load_dwordx4 v[84:87], v2, s[12:15], s24 offen offset:512 nt
  v_dot2_f32_bf16 v208, v174, s51, v200
  v_dot2_f32_bf16 v209, v174, s3, v201
  v_mfma_f32_16x16x32_bf16 v[56:59], a[60:63], a[12:15], v[56:59]
  v_dot2_f32_bf16 v210, v175, s51, v202
  v_dot2_f32_bf16 v211, v175, s3, v203
  v_cvt_pk_bf16_f32 v172, v204, v205
  v_cvt_pk_bf16_f32 v173, v206, v207
  v_cvt_pk_bf16_f32 v174, v208, v209
  v_cvt_pk_bf16_f32 v175, v210, v211
  ds_write_b128 v6, v[172:175] offset:1792
  v_dot2_f32_bf16 v204, v176, s51, v196
  v_dot2_f32_bf16 v205, v176, s3, v197
  v_dot2_f32_bf16 v206, v177, s51, v198
  v_dot2_f32_bf16 v207, v177, s3, v199
  v_dot2_f32_bf16 v208, v178, s51, v200
  v_dot2_f32_bf16 v209, v178, s3, v201
  v_dot2_f32_bf16 v210, v179, s51, v202
  v_dot2_f32_bf16 v211, v179, s3, v203
  v_cvt_pk_bf16_f32 v176, v204, v205
  v_cvt_pk_bf16_f32 v177, v206, v207
  v_cvt_pk_bf16_f32 v178, v208, v209
  v_cvt_pk_bf16_f32 v179, v210, v211
  ds_write_b128 v7, v[176:179] offset:2560
  ds_read_b128 a[64:67], v11 offset:256
  ds_read_b128 a[68:71], v12 offset:256
  ds_read_b128 a[72:75], v13 offset:256
  ds_read_b128 a[76:79], v14 offset:256
  buffer_load_dwordx4 v[120:123], v1, s[8:11], s25 offen offset:512 nt
  s_waitcnt vmcnt(14)
  v_lshlrev_b32 v196, 16, v144
  v_and_b32 v197, s44, v144
  v_lshlrev_b32 v198, 16, v145
  v_and_b32 v199, s44, v145
  v_lshlrev_b32 v200, 16, v146
  v_and_b32 v201, s44, v146
  v_lshlrev_b32 v202, 16, v147
  v_and_b32 v203, s44, v147
  v_dot2_f32_bf16 v204, v180, s51, v196
  v_dot2_f32_bf16 v205, v180, s3, v197
  v_dot2_f32_bf16 v206, v181, s51, v198
  v_dot2_f32_bf16 v207, v181, s3, v199
  v_dot2_f32_bf16 v208, v182, s51, v200
  v_dot2_f32_bf16 v209, v182, s3, v201
  v_dot2_f32_bf16 v210, v183, s51, v202
  v_dot2_f32_bf16 v211, v183, s3, v203
  v_cvt_pk_bf16_f32 v180, v204, v205
  v_cvt_pk_bf16_f32 v181, v206, v207
  v_cvt_pk_bf16_f32 v182, v208, v209
  s_waitcnt lgkmcnt(0)
  v_mfma_f32_16x16x32_bf16 v[60:63], a[64:67], a[64:67], v[60:63]
  v_cvt_pk_bf16_f32 v183, v210, v211
  ds_write_b128 v4, v[180:183] offset:512
  v_mfma_f32_16x16x32_bf16 v[64:67], a[64:67], a[192:195], v[64:67]
  v_dot2_f32_bf16 v204, v184, s51, v196
  v_dot2_f32_bf16 v205, v184, s3, v197
  v_mfma_f32_16x16x32_bf16 v[56:59], a[64:67], a[16:19], v[56:59]
  buffer_load_dwordx4 v[124:127], v1, s[8:11], s25 offen offset:1280 nt
  v_dot2_f32_bf16 v206, v185, s51, v198
  v_dot2_f32_bf16 v207, v185, s3, v199
  v_mfma_f32_16x16x32_bf16 v[60:63], a[68:71], a[68:71], v[60:63]
  v_dot2_f32_bf16 v208, v186, s51, v200
  v_dot2_f32_bf16 v209, v186, s3, v201
  v_mfma_f32_16x16x32_bf16 v[64:67], a[68:71], a[192:195], v[64:67]
  v_dot2_f32_bf16 v210, v187, s51, v202
  v_dot2_f32_bf16 v211, v187, s3, v203
  v_mfma_f32_16x16x32_bf16 v[56:59], a[68:71], a[20:23], v[56:59]
  v_cvt_pk_bf16_f32 v184, v204, v205
  v_cvt_pk_bf16_f32 v185, v206, v207
  v_mfma_f32_16x16x32_bf16 v[60:63], a[72:75], a[72:75], v[60:63]
  v_cvt_pk_bf16_f32 v186, v208, v209
  v_cvt_pk_bf16_f32 v187, v210, v211
  v_mfma_f32_16x16x32_bf16 v[64:67], a[72:75], a[192:195], v[64:67]
  ds_write_b128 v5, v[184:187] offset:1280
  s_waitcnt vmcnt(13)
  v_mfma_f32_16x16x32_bf16 v[56:59], a[72:75], a[24:27], v[56:59]
  v_dot2_f32_bf16 v204, v188, s51, v196
  v_dot2_f32_bf16 v205, v188, s3, v197
  v_mfma_f32_16x16x32_bf16 v[60:63], a[76:79], a[76:79], v[60:63]
  v_dot2_f32_bf16 v206, v189, s51, v198
  v_dot2_f32_bf16 v207, v189, s3, v199
  v_mfma_f32_16x16x32_bf16 v[64:67], a[76:79], a[192:195], v[64:67]
  buffer_load_dwordx4 v[128:131], v1, s[8:11], s26 offen offset:512 nt
  v_dot2_f32_bf16 v208, v190, s51, v200
  v_dot2_f32_bf16 v209, v190, s3, v201
  v_mfma_f32_16x16x32_bf16 v[56:59], a[76:79], a[28:31], v[56:59]
  v_dot2_f32_bf16 v210, v191, s51, v202
  v_dot2_f32_bf16 v211, v191, s3, v203
  v_cvt_pk_bf16_f32 v188, v204, v205
  v_cvt_pk_bf16_f32 v189, v206, v207
  v_cvt_pk_bf16_f32 v190, v208, v209
  v_cvt_pk_bf16_f32 v191, v210, v211
  ds_write_b128 v6, v[188:191] offset:2048
  v_dot2_f32_bf16 v204, v192, s51, v196
  v_dot2_f32_bf16 v205, v192, s3, v197
  v_dot2_f32_bf16 v206, v193, s51, v198
  v_dot2_f32_bf16 v207, v193, s3, v199
  v_dot2_f32_bf16 v208, v194, s51, v200
  v_dot2_f32_bf16 v209, v194, s3, v201
  v_dot2_f32_bf16 v210, v195, s51, v202
  v_dot2_f32_bf16 v211, v195, s3, v203
  v_cvt_pk_bf16_f32 v192, v204, v205
  v_cvt_pk_bf16_f32 v193, v206, v207
  v_cvt_pk_bf16_f32 v194, v208, v209
  v_cvt_pk_bf16_f32 v195, v210, v211
  ds_write_b128 v7, v[192:195] offset:2816
  ds_read_b128 a[80:83], v11 offset:512
  ds_read_b128 a[84:87], v12 offset:512
  ds_read_b128 a[88:91], v13 offset:512
  ds_read_b128 a[92:95], v14 offset:512
  buffer_load_dwordx4 v[132:135], v1, s[8:11], s26 offen offset:1280 nt
  s_waitcnt lgkmcnt(0)
  s_barrier
  ds_read_b64_tr_b16 a[96:97], v15 offset:0
  ds_read_b64_tr_b16 a[98:99], v15 offset:12288
  v_mfma_f32_16x16x32_bf16 v[60:63], a[80:83], a[80:83], v[60:63]
  ds_read_b64_tr_b16 a[104:105], v16 offset:0
  ds_read_b64_tr_b16 a[106:107], v16 offset:12288
  v_mfma_f32_16x16x32_bf16 v[64:67], a[80:83], a[192:195], v[64:67]
  ds_read_b64_tr_b16 a[112:113], v17 offset:0
  ds_read_b64_tr_b16 a[114:115], v17 offset:12288
  v_mfma_f32_16x16x32_bf16 v[60:63], a[84:87], a[84:87], v[60:63]
  s_add_u32 s96, s96, 1
  s_mul_i32 s27, s96, 976
  s_add_u32 s27, s27, s90
  s_cmp_gt_u32 s96, 8
  s_cselect_b32 s28, 4294966752, 0
  s_add_u32 s27, s27, s28
  s_cmp_eq_u32 s96, 8
  s_cselect_b32 s28, s91, 0
  s_cselect_b32 s23, s89, 0
  s_add_u32 s27, s27, s28
  s_mul_i32 s24, s27, 3072
  s_mul_hi_u32 s28, s27, 89478486
  s_mul_i32 s29, s28, 48
  s_sub_u32 s29, s27, s29
  s_mul_i32 s25, s28, 589824
  s_mul_i32 s29, s29, 6144
  s_add_u32 s25, s25, s29
  s_add_u32 s26, s25, 294912
  s_cmp_ge_u32 s96, 10
  s_cselect_b32 s23, 1, s23
  s_cmp_eq_u32 s23, 0
  s_cselect_b32 s10, 113246208, 0
  s_cselect_b32 s14, 28311552, 0
  buffer_load_dwordx4 v[136:139], v2, s[12:15], s24 offen offset:0 nt
  ds_read_b64_tr_b16 a[120:121], v18 offset:0
  ds_read_b64_tr_b16 a[122:123], v18 offset:12288
  v_mfma_f32_16x16x32_bf16 v[64:67], a[84:87], a[192:195], v[64:67]
  ds_read_b64_tr_b16 a[128:129], v19 offset:0
  ds_read_b64_tr_b16 a[130:131], v19 offset:12288
  v_mfma_f32_16x16x32_bf16 v[60:63], a[88:91], a[88:91], v[60:63]
  ds_read_b64_tr_b16 a[136:137], v20 offset:0
  ds_read_b64_tr_b16 a[138:139], v20 offset:12288
  v_mfma_f32_16x16x32_bf16 v[64:67], a[88:91], a[192:195], v[64:67]
  ds_read_b64_tr_b16 a[100:101], v15 offset:24576
  ds_read_b64_tr_b16 a[102:103], v15 offset:36864
  v_mfma_f32_16x16x32_bf16 v[60:63], a[92:95], a[92:95], v[60:63]
  ds_read_b64_tr_b16 a[108:109], v16 offset:24576
  ds_read_b64_tr_b16 a[110:111], v16 offset:36864
  v_mfma_f32_16x16x32_bf16 v[64:67], a[92:95], a[192:195], v[64:67]
  ds_read_b64_tr_b16 a[116:117], v17 offset:24576
  ds_read_b64_tr_b16 a[118:119], v17 offset:36864
  v_mfma_f32_16x16x32_bf16 v[56:59], a[80:83], a[32:35], v[56:59]
  ds_read_b64_tr_b16 a[124:125], v18 offset:24576
  ds_read_b64_tr_b16 a[126:127], v18 offset:36864
  v_mfma_f32_16x16x32_bf16 v[56:59], a[84:87], a[36:39], v[56:59]
  ds_read_b64_tr_b16 a[132:133], v19 offset:24576
  ds_read_b64_tr_b16 a[134:135], v19 offset:36864
  v_mfma_f32_16x16x32_bf16 v[56:59], a[88:91], a[40:43], v[56:59]
  ds_read_b64_tr_b16 a[140:141], v20 offset:24576
  ds_read_b64_tr_b16 a[142:143], v20 offset:36864
  v_mfma_f32_16x16x32_bf16 v[56:59], a[92:95], a[44:47], v[56:59]
  buffer_load_dwordx4 v[148:151], v1, s[8:11], s25 offen offset:0 nt
  v_cndmask_b32 v68, 0, v60, s[30:31]
  v_cndmask_b32 v68, v68, v61, s[32:33]
  v_cndmask_b32 v68, v68, v62, s[34:35]
  v_cndmask_b32 v68, v68, v63, s[36:37]
  v_cndmask_b32 v69, v64, v65, s[38:39]
  v_cndmask_b32 v69, v69, v66, s[40:41]
  v_add_f32_dpp v68, v68, v68 row_ror:4 row_mask:0xf bank_mask:0xf
  v_cndmask_b32 v69, v69, v67, s[42:43]
  v_mov_b32 v71, s46
  v_add_f32_dpp v68, v68, v68 row_ror:8 row_mask:0xf bank_mask:0xf
  v_mul_f32 v69, s45, v69
  v_fma_f32 v68, v68, s45, v71
  v_fma_f32 v68, -v69, v69, v68
  v_max_f32 v68, s46, v68
  v_rsq_f32 v70, v68
  v_fma_f32 v212, -v64, v28, v56
  v_fma_f32 v213, -v65, v28, v57
  v_fma_f32 v214, -v66, v28, v58
  v_fma_f32 v215, -v67, v28, v59
  v_sub_f32 v56, s22, v25
  v_mov_b32 v57, v56
  v_mov_b32 v58, v56
  v_mov_b32 v59, v56
  v_fmac_f32_dpp v56, v70, v212 quad_perm:[0,0,0,0] row_mask:0xf bank_mask:0xf
  v_fmac_f32_dpp v57, v70, v213 quad_perm:[1,1,1,1] row_mask:0xf bank_mask:0xf
  v_fmac_f32_dpp v58, v70, v214 quad_perm:[2,2,2,2] row_mask:0xf bank_mask:0xf
  v_fmac_f32_dpp v59, v70, v215 quad_perm:[3,3,3,3] row_mask:0xf bank_mask:0xf
  v_max3_f32 v71, v56, v57, v58
  v_max_f32 v71, v71, v59
  v_cmp_lt_f32 vcc, s88, v71
  v_exp_f32 v212, v56
  v_exp_f32 v213, v57
  v_exp_f32 v214, v58
  v_exp_f32 v215, v59
  s_cmp_lg_u64 vcc, 0
  s_cselect_b32 s48, 1, 0
  v_mov_b32 v72, s48
  buffer_load_dwordx4 v[152:155], v1, s[8:11], s25 offen offset:768 nt
  v_add_f32 v216, v212, v213
  v_add_f32 v217, v214, v215
  ds_write_b32 v250, v72
  v_add_f32 v216, v216, v217
  v_mul_f32_dpp v212, v70, v212 quad_perm:[0,0,0,0] row_mask:0xf bank_mask:0xf
  v_mul_f32_dpp v213, v70, v213 quad_perm:[1,1,1,1] row_mask:0xf bank_mask:0xf
  v_mul_f32_dpp v214, v70, v214 quad_perm:[2,2,2,2] row_mask:0xf bank_mask:0xf
  v_mul_f32_dpp v215, v70, v215 quad_perm:[3,3,3,3] row_mask:0xf bank_mask:0xf
  v_cvt_pk_bf16_f32 v74, v212, v213
  v_cvt_pk_bf16_f32 v75, v214, v215
  ds_write_b64 v23, v[74:75]
  s_waitcnt lgkmcnt(0)
  s_barrier
  ds_read_b128 v[232:235], v251
  buffer_load_dwordx4 v[156:159], v1, s[8:11], s26 offen offset:0 nt
  ds_read_b128 v[224:227], v24
  ds_read_b128 v[228:231], v24 offset:1024
  v_mul_f32 v217, v212, v64
  v_fma_f32 v217, v213, v65, v217
  v_fma_f32 v217, v214, v66, v217
  v_fma_f32 v217, v215, v67, v217
  s_waitcnt lgkmcnt(2)
  v_or3_b32 v71, v232, v233, v234
  v_or_b32 v71, v71, v235
  v_cmp_ne_u32 vcc, 0, v71
  s_cbranch_vccz standalone__detection_seg_dino__vision_kernel_lz4
  s_waitcnt lgkmcnt(0)
  v_max3_f32 v71, v56, v57, v58
  v_max_f32 v71, v71, v59
  v_mov_b32 v72, v71
  s_nop 1
  v_permlane32_swap_b32 v71, v72
  v_max_f32 v71, v71, v72
  v_mov_b32 v72, v71
  s_nop 1
  v_permlane16_swap_b32 v71, v72
  v_max_f32 v71, v71, v72
  ds_write_b32 v21, v71
  s_waitcnt lgkmcnt(0)
  s_barrier
  ds_read_b128 v[232:235], v22
  s_waitcnt lgkmcnt(0)
  v_max3_f32 v71, v232, v233, v234
  v_max3_f32 v71, v71, v235, 0
  v_add_f32 v72, v25, v71
  v_and_b32 v72, s87, v72
  v_sub_f32 v71, v72, v25
  v_mov_b32 v25, v72
  v_sub_f32 v73, 0, v71
  v_exp_f32 v73, v73
  v_sub_f32 v56, v56, v71
  v_sub_f32 v57, v57, v71
  v_sub_f32 v58, v58, v71
  v_sub_f32 v59, v59, v71
  v_mul_f32 v32, v32, v73
  v_mul_f32 v33, v33, v73
  v_mul_f32 v34, v34, v73
  v_mul_f32 v35, v35, v73
  v_mul_f32 v36, v36, v73
  v_mul_f32 v37, v37, v73
  v_mul_f32 v38, v38, v73
  v_mul_f32 v39, v39, v73
  v_mul_f32 v40, v40, v73
  v_mul_f32 v41, v41, v73
  v_mul_f32 v42, v42, v73
  v_mul_f32 v43, v43, v73
  v_mul_f32 v44, v44, v73
  v_mul_f32 v45, v45, v73
  v_mul_f32 v46, v46, v73
  v_mul_f32 v47, v47, v73
  v_mul_f32 v48, v48, v73
  v_mul_f32 v49, v49, v73
  v_mul_f32 v50, v50, v73
  v_mul_f32 v51, v51, v73
  v_mul_f32 v52, v52, v73
  v_mul_f32 v53, v53, v73
  v_mul_f32 v54, v54, v73
  v_mul_f32 v55, v55, v73
  v_mul_f32 v26, v26, v73
  v_mul_f32 v27, v27, v73
  v_exp_f32 v212, v56
  v_exp_f32 v213, v57
  v_exp_f32 v214, v58
  v_exp_f32 v215, v59
  v_add_f32 v216, v212, v213
  v_add_f32 v217, v214, v215
  v_add_f32 v216, v216, v217
  v_mul_f32_dpp v212, v70, v212 quad_perm:[0,0,0,0] row_mask:0xf bank_mask:0xf
  v_mul_f32_dpp v213, v70, v213 quad_perm:[1,1,1,1] row_mask:0xf bank_mask:0xf
  v_mul_f32_dpp v214, v70, v214 quad_perm:[2,2,2,2] row_mask:0xf bank_mask:0xf
  v_mul_f32_dpp v215, v70, v215 quad_perm:[3,3,3,3] row_mask:0xf bank_mask:0xf
  v_cvt_pk_bf16_f32 v74, v212, v213
  v_cvt_pk_bf16_f32 v75, v214, v215
  ds_write_b64 v23, v[74:75]
  v_mul_f32 v217, v212, v64
  v_fma_f32 v217, v213, v65, v217
  v_fma_f32 v217, v214, v66, v217
  v_fma_f32 v217, v215, v67, v217
  s_waitcnt lgkmcnt(0)
  s_barrier
  ds_read_b128 v[224:227], v24
  ds_read_b128 v[228:231], v24 offset:1024
  s_waitcnt lgkmcnt(0)
  s_nop 7
standalone__detection_seg_dino__vision_kernel_lz4:
  v_add_f32 v26, v26, v216
  buffer_load_dwordx4 v[160:163], v1, s[8:11], s26 offen offset:768 nt
  v_add_f32 v27, v27, v217
  s_add_u32 s101, s101, 1
  s_cmp_lt_u32 s101, 3
  s_cbranch_scc1 standalone__detection_seg_dino__vision_kernel_zloop
standalone__detection_seg_dino__vision_kernel_zexit:
  s_waitcnt vmcnt(0)
  v_bfi_b32 v71, s93, v8, v25
  v_bfe_u32 v72, v0, 2, 2
  v_lshlrev_b32 v72, 12, v72
  v_and_b32 v73, 3, v0
  v_lshl_add_u32 v72, v73, 2, v72
  s_lshl_b32 s48, s2, 4
  s_add_u32 s48, s48, 143360
  s_cmp_eq_u32 s20, 0
  s_cbranch_scc0 standalone__detection_seg_dino__vision_kernel_m2skip
  s_mov_b64 exec, 0xffff
  buffer_store_dword v71, v72, s[16:19], s48 offen sc1
  s_mov_b64 exec, -1
standalone__detection_seg_dino__vision_kernel_m2skip:
  v_mov_b32 v72, v27
  s_nop 1
  v_permlane32_swap_b32 v27, v72
  v_add_f32 v27, v27, v72
  v_mov_b32 v72, v27
  s_waitcnt lgkmcnt(1)
  v_mfma_f32_16x16x32_bf16 v[32:35], a[96:99], v[224:227], v[32:35]
  v_permlane16_swap_b32 v27, v72
  v_add_f32 v27, v27, v72
  v_mfma_f32_16x16x32_bf16 v[36:39], a[104:107], v[224:227], v[36:39]
  ds_write_b32 v21, v27 offset:256
  v_mov_b32 v72, v26
  v_mfma_f32_16x16x32_bf16 v[40:43], a[112:115], v[224:227], v[40:43]
  s_nop 0
  v_permlane32_swap_b32 v26, v72
  v_add_f32 v26, v26, v72
  v_mfma_f32_16x16x32_bf16 v[44:47], a[120:123], v[224:227], v[44:47]
  v_mov_b32 v72, v26
  s_nop 1
  v_permlane16_swap_b32 v26, v72
  v_mfma_f32_16x16x32_bf16 v[48:51], a[128:131], v[224:227], v[48:51]
  v_add_f32 v26, v26, v72
  ds_write_b32 v21, v26
  v_mfma_f32_16x16x32_bf16 v[52:55], a[136:139], v[224:227], v[52:55]
  v_lshrrev_b32 v56, 2, v0
  v_lshlrev_b32 v56, 14, v56
  s_waitcnt lgkmcnt(2)
  v_mfma_f32_16x16x32_bf16 v[32:35], a[100:103], v[228:231], v[32:35]
  v_and_b32 v57, 3, v0
  v_lshl_add_u32 v56, v57, 4, v56
  v_mfma_f32_16x16x32_bf16 v[36:39], a[108:111], v[228:231], v[36:39]
  s_mul_i32 s24, s20, 786432
  s_lshl_b32 s25, s2, 6
  v_mfma_f32_16x16x32_bf16 v[40:43], a[116:119], v[228:231], v[40:43]
  s_add_u32 s24, s24, s25
  s_add_u32 s24, s24, 262144
  v_mfma_f32_16x16x32_bf16 v[44:47], a[124:127], v[228:231], v[44:47]
  v_mov_b32 v71, 0x00010001
  v_mfma_f32_16x16x32_bf16 v[48:51], a[132:135], v[228:231], v[48:51]
  v_mfma_f32_16x16x32_bf16 v[52:55], a[140:143], v[228:231], v[52:55]
  s_waitcnt lgkmcnt(0)
  s_barrier
  ds_read_b128 v[60:63], v22 offset:256
  ds_read_b128 v[64:67], v22
  s_waitcnt lgkmcnt(1)
  v_add_f32 v60, v60, v61
  v_add_f32 v62, v62, v63
  v_add_f32 v60, v60, v62
  v_mul_f32 v68, s45, v60
  v_sub_f32 v68, 0, v68
  v_mov_b32 v69, v68
  v_pk_add_f32 v[32:33], v[32:33], v[68:69]
  v_pk_add_f32 v[34:35], v[34:35], v[68:69]
  v_pk_add_f32 v[36:37], v[36:37], v[68:69]
  v_pk_add_f32 v[38:39], v[38:39], v[68:69]
  v_cvt_pk_bf16_f32 v32, v32, v33
  v_cvt_pk_bf16_f32 v33, v34, v35
  v_cvt_pk_bf16_f32 v34, v36, v37
  v_cvt_pk_bf16_f32 v35, v38, v39
  v_bfi_b32 v32, v71, s4, v32
  v_bfi_b32 v33, v71, s5, v33
  v_bfi_b32 v34, v71, s6, v34
  v_bfi_b32 v35, v71, s7, v35
  buffer_store_dwordx4 v[32:35], v56, s[16:19], s24 offen sc1
  s_add_u32 s24, s24, 262144
  v_pk_add_f32 v[40:41], v[40:41], v[68:69]
  v_pk_add_f32 v[42:43], v[42:43], v[68:69]
  v_pk_add_f32 v[44:45], v[44:45], v[68:69]
  v_pk_add_f32 v[46:47], v[46:47], v[68:69]
  v_cvt_pk_bf16_f32 v40, v40, v41
  v_cvt_pk_bf16_f32 v41, v42, v43
  v_cvt_pk_bf16_f32 v42, v44, v45
  v_cvt_pk_bf16_f32 v43, v46, v47
  v_bfi_b32 v40, v71, s4, v40
  v_bfi_b32 v41, v71, s5, v41
  v_bfi_b32 v42, v71, s6, v42
  v_bfi_b32 v43, v71, s7, v43
  buffer_store_dwordx4 v[40:43], v56, s[16:19], s24 offen sc1
  s_add_u32 s24, s24, 262144
  v_pk_add_f32 v[48:49], v[48:49], v[68:69]
  v_pk_add_f32 v[50:51], v[50:51], v[68:69]
  v_pk_add_f32 v[52:53], v[52:53], v[68:69]
  v_pk_add_f32 v[54:55], v[54:55], v[68:69]
  v_cvt_pk_bf16_f32 v48, v48, v49
  v_cvt_pk_bf16_f32 v49, v50, v51
  v_cvt_pk_bf16_f32 v50, v52, v53
  v_cvt_pk_bf16_f32 v51, v54, v55
  v_bfi_b32 v48, v71, s4, v48
  v_bfi_b32 v49, v71, s5, v49
  v_bfi_b32 v50, v71, s6, v50
  v_bfi_b32 v51, v71, s7, v51
  buffer_store_dwordx4 v[48:51], v56, s[16:19], s24 offen sc1
  s_cmp_lg_u32 s20, 0
  s_cbranch_scc1 standalone__detection_seg_dino__vision_kernel_red
  s_waitcnt lgkmcnt(0)
  v_add_f32 v64, v64, v65
  v_add_f32 v66, v66, v67
  v_add_f32 v65, v64, v66
  v_mov_b32 v64, v25
  v_mov_b32 v66, 0
  v_mov_b32 v67, v8
  s_lshl_b32 s24, s2, 8
  s_add_u32 s24, s24, 77824
  s_mov_b64 exec, 0xffff
  buffer_store_dwordx4 v[64:67], v3, s[16:19], s24 offen sc1
  s_mov_b64 exec, -1
standalone__detection_seg_dino__vision_kernel_red:
  s_cmp_ge_u32 s21, 192
  s_cbranch_scc1 standalone__detection_seg_dino__vision_kernel_sdone
  s_lshr_b32 s24, s21, 4
  s_lshr_b32 s25, s21, 2
  s_and_b32 s25, s25, 3
  s_and_b32 s26, s21, 3
  v_and_b32 v56, 3, v0
  v_mov_b32 v58, v3
  v_lshlrev_b32 v59, 2, v0
  s_lshl_b32 s27, s21, 14
  s_lshl_b32 s28, s20, 12
  s_add_u32 s27, s27, s28
  s_add_u32 s27, s27, 262144
  s_lshl_b32 s29, s20, 10
  s_lshl_b32 s28, s26, 12
  s_add_u32 s29, s29, s28
  s_add_u32 s29, s29, 143360
  s_mov_b32 s50, 15
  s_mov_b32 s51, 15
  s_mov_b32 s92, 0
  buffer_load_dword v76, v59, s[16:19], s29 offen offset:0 sc1
  buffer_load_dword v77, v59, s[16:19], s29 offen offset:256 sc1
  buffer_load_dword v78, v59, s[16:19], s29 offen offset:512 sc1
  buffer_load_dword v79, v59, s[16:19], s29 offen offset:768 sc1
  s_waitcnt vmcnt(0)
  s_bitcmp0_b32 s50, 0
  s_cbranch_scc1 standalone__detection_seg_dino__vision_kernel_rr_e0
  v_xor_b32 v76, v76, v8
  v_and_b32 v60, s93, v76
  v_cmp_ne_u32 vcc, 0, v60
  s_cbranch_vccnz standalone__detection_seg_dino__vision_kernel_rr_e0
  s_bitset0_b32 s50, 0
standalone__detection_seg_dino__vision_kernel_rr_e0:
  s_bitcmp0_b32 s50, 1
  s_cbranch_scc1 standalone__detection_seg_dino__vision_kernel_rr_e1
  v_xor_b32 v77, v77, v8
  v_and_b32 v60, s93, v77
  v_cmp_ne_u32 vcc, 0, v60
  s_cbranch_vccnz standalone__detection_seg_dino__vision_kernel_rr_e1
  s_bitset0_b32 s50, 1
standalone__detection_seg_dino__vision_kernel_rr_e1:
  s_bitcmp0_b32 s50, 2
  s_cbranch_scc1 standalone__detection_seg_dino__vision_kernel_rr_e2
  v_xor_b32 v78, v78, v8
  v_and_b32 v60, s93, v78
  v_cmp_ne_u32 vcc, 0, v60
  s_cbranch_vccnz standalone__detection_seg_dino__vision_kernel_rr_e2
  s_bitset0_b32 s50, 2
standalone__detection_seg_dino__vision_kernel_rr_e2:
  s_bitcmp0_b32 s50, 3
  s_cbranch_scc1 standalone__detection_seg_dino__vision_kernel_rr_e3
  v_xor_b32 v79, v79, v8
  v_and_b32 v60, s93, v79
  v_cmp_ne_u32 vcc, 0, v60
  s_cbranch_vccnz standalone__detection_seg_dino__vision_kernel_rr_e3
  s_bitset0_b32 s50, 3
standalone__detection_seg_dino__vision_kernel_rr_e3:
standalone__detection_seg_dino__vision_kernel_rr_loop:
  s_andn2_b32 s47, s51, s50
  s_bcnt1_i32_b32 s48, s50
  s_cmp_le_u32 s48, 0
  s_cselect_b32 s47, s51, s47
  s_bitcmp0_b32 s50, 0
  s_cbranch_scc1 standalone__detection_seg_dino__vision_kernel_rr_a0
  buffer_load_dword v76, v59, s[16:19], s29 offen offset:0 sc1
standalone__detection_seg_dino__vision_kernel_rr_a0:
  s_bitcmp0_b32 s47, 0
  s_cbranch_scc1 standalone__detection_seg_dino__vision_kernel_rr_b0
  buffer_load_dwordx4 v[108:111], v58, s[16:19], s27 offen offset:0 sc1
standalone__detection_seg_dino__vision_kernel_rr_b0:
  s_bitcmp0_b32 s50, 1
  s_cbranch_scc1 standalone__detection_seg_dino__vision_kernel_rr_a1
  buffer_load_dword v77, v59, s[16:19], s29 offen offset:256 sc1
standalone__detection_seg_dino__vision_kernel_rr_a1:
  s_bitcmp0_b32 s47, 1
  s_cbranch_scc1 standalone__detection_seg_dino__vision_kernel_rr_b1
  buffer_load_dwordx4 v[112:115], v58, s[16:19], s27 offen offset:1024 sc1
standalone__detection_seg_dino__vision_kernel_rr_b1:
  s_bitcmp0_b32 s50, 2
  s_cbranch_scc1 standalone__detection_seg_dino__vision_kernel_rr_a2
  buffer_load_dword v78, v59, s[16:19], s29 offen offset:512 sc1
standalone__detection_seg_dino__vision_kernel_rr_a2:
  s_bitcmp0_b32 s47, 2
  s_cbranch_scc1 standalone__detection_seg_dino__vision_kernel_rr_b2
  buffer_load_dwordx4 v[116:119], v58, s[16:19], s27 offen offset:2048 sc1
standalone__detection_seg_dino__vision_kernel_rr_b2:
  s_bitcmp0_b32 s50, 3
  s_cbranch_scc1 standalone__detection_seg_dino__vision_kernel_rr_a3
  buffer_load_dword v79, v59, s[16:19], s29 offen offset:768 sc1
standalone__detection_seg_dino__vision_kernel_rr_a3:
  s_bitcmp0_b32 s47, 3
  s_cbranch_scc1 standalone__detection_seg_dino__vision_kernel_rr_b3
  buffer_load_dwordx4 v[120:123], v58, s[16:19], s27 offen offset:3072 sc1
standalone__detection_seg_dino__vision_kernel_rr_b3:
  s_waitcnt vmcnt(0)
  s_bitcmp0_b32 s47, 0
  s_cbranch_scc1 standalone__detection_seg_dino__vision_kernel_rr_c0
  v_xor_b32 v108, s4, v108
  v_xor_b32 v109, s5, v109
  v_xor_b32 v110, s6, v110
  v_xor_b32 v111, s7, v111
  v_or3_b32 v60, v108, v109, v110
  v_or_b32 v60, v60, v111
  v_and_b32 v60, 0x00010001, v60
  v_cmp_ne_u32 vcc, 0, v60
  s_cbranch_vccnz standalone__detection_seg_dino__vision_kernel_rr_c0
  s_bitset0_b32 s51, 0
standalone__detection_seg_dino__vision_kernel_rr_c0:
  s_bitcmp0_b32 s50, 0
  s_cbranch_scc1 standalone__detection_seg_dino__vision_kernel_rr_d0
  v_xor_b32 v76, v76, v8
  v_and_b32 v60, s93, v76
  v_cmp_ne_u32 vcc, 0, v60
  s_cbranch_vccnz standalone__detection_seg_dino__vision_kernel_rr_d0
  s_bitset0_b32 s50, 0
standalone__detection_seg_dino__vision_kernel_rr_d0:
  s_bitcmp0_b32 s47, 1
  s_cbranch_scc1 standalone__detection_seg_dino__vision_kernel_rr_c1
  v_xor_b32 v112, s4, v112
  v_xor_b32 v113, s5, v113
  v_xor_b32 v114, s6, v114
  v_xor_b32 v115, s7, v115
  v_or3_b32 v60, v112, v113, v114
  v_or_b32 v60, v60, v115
  v_and_b32 v60, 0x00010001, v60
  v_cmp_ne_u32 vcc, 0, v60
  s_cbranch_vccnz standalone__detection_seg_dino__vision_kernel_rr_c1
  s_bitset0_b32 s51, 1
standalone__detection_seg_dino__vision_kernel_rr_c1:
  s_bitcmp0_b32 s50, 1
  s_cbranch_scc1 standalone__detection_seg_dino__vision_kernel_rr_d1
  v_xor_b32 v77, v77, v8
  v_and_b32 v60, s93, v77
  v_cmp_ne_u32 vcc, 0, v60
  s_cbranch_vccnz standalone__detection_seg_dino__vision_kernel_rr_d1
  s_bitset0_b32 s50, 1
standalone__detection_seg_dino__vision_kernel_rr_d1:
  s_bitcmp0_b32 s47, 2
  s_cbranch_scc1 standalone__detection_seg_dino__vision_kernel_rr_c2
  v_xor_b32 v116, s4, v116
  v_xor_b32 v117, s5, v117
  v_xor_b32 v118, s6, v118
  v_xor_b32 v119, s7, v119
  v_or3_b32 v60, v116, v117, v118
  v_or_b32 v60, v60, v119
  v_and_b32 v60, 0x00010001, v60
  v_cmp_ne_u32 vcc, 0, v60
  s_cbranch_vccnz standalone__detection_seg_dino__vision_kernel_rr_c2
  s_bitset0_b32 s51, 2
standalone__detection_seg_dino__vision_kernel_rr_c2:
  s_bitcmp0_b32 s50, 2
  s_cbranch_scc1 standalone__detection_seg_dino__vision_kernel_rr_d2
  v_xor_b32 v78, v78, v8
  v_and_b32 v60, s93, v78
  v_cmp_ne_u32 vcc, 0, v60
  s_cbranch_vccnz standalone__detection_seg_dino__vision_kernel_rr_d2
  s_bitset0_b32 s50, 2
standalone__detection_seg_dino__vision_kernel_rr_d2:
  s_bitcmp0_b32 s47, 3
  s_cbranch_scc1 standalone__detection_seg_dino__vision_kernel_rr_c3
  v_xor_b32 v120, s4, v120
  v_xor_b32 v121, s5, v121
  v_xor_b32 v122, s6, v122
  v_xor_b32 v123, s7, v123
  v_or3_b32 v60, v120, v121, v122
  v_or_b32 v60, v60, v123
  v_and_b32 v60, 0x00010001, v60
  v_cmp_ne_u32 vcc, 0, v60
  s_cbranch_vccnz standalone__detection_seg_dino__vision_kernel_rr_c3
  s_bitset0_b32 s51, 3
standalone__detection_seg_dino__vision_kernel_rr_c3:
  s_bitcmp0_b32 s50, 3
  s_cbranch_scc1 standalone__detection_seg_dino__vision_kernel_rr_d3
  v_xor_b32 v79, v79, v8
  v_and_b32 v60, s93, v79
  v_cmp_ne_u32 vcc, 0, v60
  s_cbranch_vccnz standalone__detection_seg_dino__vision_kernel_rr_d3
  s_bitset0_b32 s50, 3
standalone__detection_seg_dino__vision_kernel_rr_d3:
  s_or_b32 s48, s50, s51
  s_cmp_eq_u32 s48, 0
  s_cbranch_scc1 standalone__detection_seg_dino__vision_kernel_rr_done
  s_add_u32 s92, s92, 1
  s_cmp_lt_u32 s92, 1048576
  s_cbranch_scc1 standalone__detection_seg_dino__vision_kernel_rr_loop
standalone__detection_seg_dino__vision_kernel_rr_done:
  s_nop 7
  v_max3_f32 v61, v76, v77, v78
  v_max_f32 v61, v61, v79
  v_mov_b32 v63, 0x8000
  s_nop 0
  v_max_f32_dpp v61, v61, v61 row_ror:4 row_mask:0xf bank_mask:0xf
  v_lshl_or_b32 v140, v108, 16, v63
  v_and_or_b32 v141, v108, s44, v63
  v_lshl_or_b32 v142, v109, 16, v63
  v_and_or_b32 v143, v109, s44, v63
  v_lshl_or_b32 v144, v110, 16, v63
  v_and_or_b32 v145, v110, s44, v63
  v_lshl_or_b32 v146, v111, 16, v63
  v_and_or_b32 v147, v111, s44, v63
  v_max_f32_dpp v61, v61, v61 row_ror:8 row_mask:0xf bank_mask:0xf
  v_mov_b32 v62, v61
  s_nop 1
  v_permlane32_swap_b32 v61, v62
  v_max_f32 v61, v61, v62
  v_mov_b32 v62, v61
  s_nop 1
  v_permlane16_swap_b32 v61, v62
  v_max_f32 v61, v61, v62
  v_sub_f32 v76, v76, v61
  v_sub_f32 v77, v77, v61
  v_sub_f32 v78, v78, v61
  v_sub_f32 v79, v79, v61
  v_exp_f32 v76, v76
  v_exp_f32 v77, v77
  v_exp_f32 v78, v78
  v_exp_f32 v79, v79
  s_waitcnt lgkmcnt(0)
  v_mul_f32 v64, v76, v140
  v_mul_f32 v65, v76, v141
  v_mul_f32 v66, v76, v142
  v_mul_f32 v67, v76, v143
  v_mul_f32 v68, v76, v144
  v_mul_f32 v69, v76, v145
  v_mul_f32 v70, v76, v146
  v_mul_f32 v71, v76, v147
  v_lshl_or_b32 v140, v112, 16, v63
  v_and_or_b32 v141, v112, s44, v63
  v_lshl_or_b32 v142, v113, 16, v63
  v_and_or_b32 v143, v113, s44, v63
  v_lshl_or_b32 v144, v114, 16, v63
  v_and_or_b32 v145, v114, s44, v63
  v_lshl_or_b32 v146, v115, 16, v63
  v_and_or_b32 v147, v115, s44, v63
  v_fma_f32 v64, v77, v140, v64
  v_fma_f32 v65, v77, v141, v65
  v_fma_f32 v66, v77, v142, v66
  v_fma_f32 v67, v77, v143, v67
  v_fma_f32 v68, v77, v144, v68
  v_fma_f32 v69, v77, v145, v69
  v_fma_f32 v70, v77, v146, v70
  v_fma_f32 v71, v77, v147, v71
  v_lshl_or_b32 v140, v116, 16, v63
  v_and_or_b32 v141, v116, s44, v63
  v_lshl_or_b32 v142, v117, 16, v63
  v_and_or_b32 v143, v117, s44, v63
  v_lshl_or_b32 v144, v118, 16, v63
  v_and_or_b32 v145, v118, s44, v63
  v_lshl_or_b32 v146, v119, 16, v63
  v_and_or_b32 v147, v119, s44, v63
  v_fma_f32 v64, v78, v140, v64
  v_fma_f32 v65, v78, v141, v65
  v_fma_f32 v66, v78, v142, v66
  v_fma_f32 v67, v78, v143, v67
  v_fma_f32 v68, v78, v144, v68
  v_fma_f32 v69, v78, v145, v69
  v_fma_f32 v70, v78, v146, v70
  v_fma_f32 v71, v78, v147, v71
  v_lshl_or_b32 v140, v120, 16, v63
  v_and_or_b32 v141, v120, s44, v63
  v_lshl_or_b32 v142, v121, 16, v63
  v_and_or_b32 v143, v121, s44, v63
  v_lshl_or_b32 v144, v122, 16, v63
  v_and_or_b32 v145, v122, s44, v63
  v_lshl_or_b32 v146, v123, 16, v63
  v_and_or_b32 v147, v123, s44, v63
  v_fma_f32 v64, v79, v140, v64
  v_fma_f32 v65, v79, v141, v65
  v_fma_f32 v66, v79, v142, v66
  v_fma_f32 v67, v79, v143, v67
  v_fma_f32 v68, v79, v144, v68
  v_fma_f32 v69, v79, v145, v69
  v_fma_f32 v70, v79, v146, v70
  v_fma_f32 v71, v79, v147, v71
  v_permlane32_swap_b32 v64, v68
  v_permlane32_swap_b32 v65, v69
  v_permlane32_swap_b32 v66, v70
  v_permlane32_swap_b32 v67, v71
  v_add_f32 v64, v64, v68
  v_add_f32 v65, v65, v69
  v_add_f32 v66, v66, v70
  v_add_f32 v67, v67, v71
  s_nop 0
  v_permlane16_swap_b32 v64, v66
  v_permlane16_swap_b32 v65, v67
  v_add_f32 v64, v64, v66
  v_add_f32 v65, v65, v67
  s_nop 0
  v_add_f32_dpp v64, v64, v64 row_ror:4 row_mask:0xf bank_mask:0xf
  v_add_f32_dpp v65, v65, v65 row_ror:4 row_mask:0xf bank_mask:0xf
  v_lshlrev_b32 v72, 3, v0
  s_lshl_b32 s28, s20, 9
  v_add_u32 v73, s28, v72
  v_add_f32_dpp v64, v64, v64 row_ror:8 row_mask:0xf bank_mask:0xf
  v_add_f32_dpp v65, v65, v65 row_ror:8 row_mask:0xf bank_mask:0xf
  v_lshlrev_b32 v74, 2, v0
  s_lshl_b32 s28, s20, 8
  v_add_u32 v75, s28, v74
  ds_write_b64 v73, v[64:65]
  ds_write_b32 v75, v61 offset:2048
  s_waitcnt lgkmcnt(0)
  s_barrier
  s_cmp_lg_u32 s20, 0
  s_cbranch_scc1 standalone__detection_seg_dino__vision_kernel_sdone
  ds_read_b32 v84, v74 offset:2048
  ds_read_b64 v[76:77], v72 offset:0
  ds_read_b32 v85, v74 offset:2304
  ds_read_b64 v[78:79], v72 offset:512
  ds_read_b32 v86, v74 offset:2560
  ds_read_b64 v[80:81], v72 offset:1024
  ds_read_b32 v87, v74 offset:2816
  ds_read_b64 v[82:83], v72 offset:1536
  v_lshrrev_b32 v66, 4, v0
  v_lshlrev_b32 v66, 3, v66
  v_lshl_add_u32 v66, v56, 5, v66
  s_lshl_b32 s24, s21, 7
  s_add_u32 s24, s24, 53248
  s_waitcnt lgkmcnt(3)
  v_max3_f32 v61, v84, v85, v86
  s_waitcnt lgkmcnt(1)
  v_max_f32 v61, v61, v87
  v_sub_f32 v84, v84, v61
  v_sub_f32 v85, v85, v61
  v_sub_f32 v86, v86, v61
  v_sub_f32 v87, v87, v61
  v_exp_f32 v84, v84
  v_exp_f32 v85, v85
  v_exp_f32 v86, v86
  v_exp_f32 v87, v87
  v_mul_f32 v64, v84, v76
  v_mul_f32 v65, v84, v77
  v_fma_f32 v64, v85, v78, v64
  v_fma_f32 v65, v85, v79, v65
  v_fma_f32 v64, v86, v80, v64
  v_fma_f32 v65, v86, v81, v65
  s_waitcnt lgkmcnt(0)
  v_fma_f32 v64, v87, v82, v64
  v_fma_f32 v65, v87, v83, v65
  v_bfi_b32 v64, s93, v8, v64
  v_bfi_b32 v65, s93, v8, v65
  s_mov_b32 exec_lo, 0x000f000f
  s_mov_b32 exec_hi, 0x000f000f
  buffer_store_dwordx2 v[64:65], v66, s[16:19], s24 offen sc1
standalone__detection_seg_dino__vision_kernel_sdone:
  s_endpgm
standalone__detection_seg_dino__vision_kernel_special:
  s_waitcnt lgkmcnt(0)
  s_load_dwordx2 s[4:5], s[0:1], 0
  s_load_dwordx4 s[8:11], s[0:1], 24
  s_load_dwordx4 s[12:15], s[0:1], 40
  s_load_dwordx2 s[6:7], s[0:1], 56
  v_lshlrev_b32 v1, 4, v0
  v_and_b32 v2, 15, v0
  v_lshrrev_b32 v3, 4, v0
  v_mul_u32_u24 v5, 784, v2
  v_lshl_add_u32 v5, v3, 4, v5
  v_add_u32 v6, 0, v1
  v_lshrrev_b32 v7, 8, v6
  v_mul_u32_u24 v7, 21846, v7
  v_lshrrev_b32 v7, 16, v7
  v_lshl_add_u32 v216, v7, 4, v6
  v_add_u32 v6, 1024, v1
  v_lshrrev_b32 v7, 8, v6
  v_mul_u32_u24 v7, 21846, v7
  v_lshrrev_b32 v7, 16, v7
  v_lshl_add_u32 v217, v7, 4, v6
  v_add_u32 v6, 2048, v1
  v_lshrrev_b32 v7, 8, v6
  v_mul_u32_u24 v7, 21846, v7
  v_lshrrev_b32 v7, 16, v7
  v_lshl_add_u32 v218, v7, 4, v6
  v_add_u32 v6, 3072, v1
  v_lshrrev_b32 v7, 8, v6
  v_mul_u32_u24 v7, 21846, v7
  v_lshrrev_b32 v7, 16, v7
  v_lshl_add_u32 v219, v7, 4, v6
  v_add_u32 v6, 4096, v1
  v_lshrrev_b32 v7, 8, v6
  v_mul_u32_u24 v7, 21846, v7
  v_lshrrev_b32 v7, 16, v7
  v_lshl_add_u32 v220, v7, 4, v6
  v_add_u32 v6, 5120, v1
  v_lshrrev_b32 v7, 8, v6
  v_mul_u32_u24 v7, 21846, v7
  v_lshrrev_b32 v7, 16, v7
  v_lshl_add_u32 v221, v7, 4, v6
  v_add_u32 v6, 6144, v1
  v_lshrrev_b32 v7, 8, v6
  v_mul_u32_u24 v7, 21846, v7
  v_lshrrev_b32 v7, 16, v7
  v_lshl_add_u32 v222, v7, 4, v6
  v_add_u32 v6, 7168, v1
  v_lshrrev_b32 v7, 8, v6
  v_mul_u32_u24 v7, 21846, v7
  v_lshrrev_b32 v7, 16, v7
  v_lshl_add_u32 v223, v7, 4, v6
  v_add_u32 v6, 8192, v1
  v_lshrrev_b32 v7, 8, v6
  v_mul_u32_u24 v7, 21846, v7
  v_lshrrev_b32 v7, 16, v7
  v_lshl_add_u32 v224, v7, 4, v6
  v_add_u32 v6, 9216, v1
  v_lshrrev_b32 v7, 8, v6
  v_mul_u32_u24 v7, 21846, v7
  v_lshrrev_b32 v7, 16, v7
  v_lshl_add_u32 v225, v7, 4, v6
  v_add_u32 v6, 10240, v1
  v_lshrrev_b32 v7, 8, v6
  v_mul_u32_u24 v7, 21846, v7
  v_lshrrev_b32 v7, 16, v7
  v_lshl_add_u32 v226, v7, 4, v6
  v_add_u32 v6, 11264, v1
  v_lshrrev_b32 v7, 8, v6
  v_mul_u32_u24 v7, 21846, v7
  v_lshrrev_b32 v7, 16, v7
  v_lshl_add_u32 v227, v7, 4, v6
  s_waitcnt lgkmcnt(0)
  s_load_dword s94, s[22:23], 0
  s_mov_b32 s16, s22
  s_and_b32 s17, s23, 0xffff
  s_mov_b32 s18, 3407872
  s_mov_b32 s19, 0x20000
  s_mov_b32 s24, s8
  s_and_b32 s25, s9, 0xffff
  s_mov_b32 s26, 294912
  s_mov_b32 s27, 0x20000
  s_mov_b32 s28, s10
  s_and_b32 s29, s11, 0xffff
  s_mov_b32 s30, 294912
  s_mov_b32 s31, 0x20000
  s_mov_b32 s32, s4
  s_and_b32 s33, s5, 0xffff
  s_mov_b32 s34, 12288
  s_mov_b32 s35, 0x20000
  s_mov_b32 s36, s12
  s_and_b32 s37, s13, 0xffff
  s_mov_b32 s38, 294912
  s_mov_b32 s39, 0x20000
  s_mov_b32 s40, s14
  s_and_b32 s41, s15, 0xffff
  s_mov_b32 s42, 294912
  s_mov_b32 s43, 0x20000
  s_mov_b32 s44, s6
  s_and_b32 s45, s7, 0xffff
  s_mov_b32 s46, 12288
  s_mov_b32 s47, 0x20000
  s_cmp_ge_u32 s100, 6
  s_cbranch_scc1 standalone__detection_seg_dino__vision_kernel_st2
  v_lshrrev_b32 v7, 3, v0
  v_and_b32 v8, 7, v0
  v_mul_u32_u24 v9, 768, v7
  v_lshl_add_u32 v9, v8, 4, v9
  v_mul_u32_u24 v10, 144, v7
  v_lshl_add_u32 v10, v8, 4, v10
  s_mul_i32 s48, s20, 3072
  buffer_load_dwordx4 v[16:19], v1, s[32:35], s48 offen offset:0
  buffer_load_dwordx4 v[20:23], v1, s[32:35], s48 offen offset:1024
  buffer_load_dwordx4 v[24:27], v1, s[32:35], s48 offen offset:2048
  s_lshl_b32 s48, s100, 7
  s_mul_i32 s49, s20, 73728
  s_add_u32 s48, s48, s49
  buffer_load_dwordx4 v[64:67], v9, s[24:27], s48 offen
  s_add_u32 s48, s48, 6144
  buffer_load_dwordx4 v[68:71], v9, s[24:27], s48 offen
  s_add_u32 s48, s48, 6144
  buffer_load_dwordx4 v[72:75], v9, s[24:27], s48 offen
  s_add_u32 s48, s48, 6144
  buffer_load_dwordx4 v[76:79], v9, s[24:27], s48 offen
  s_add_u32 s48, s48, 6144
  buffer_load_dwordx4 v[80:83], v9, s[24:27], s48 offen
  s_add_u32 s48, s48, 6144
  buffer_load_dwordx4 v[84:87], v9, s[24:27], s48 offen
  s_add_u32 s48, s48, 6144
  buffer_load_dwordx4 v[88:91], v9, s[24:27], s48 offen
  s_add_u32 s48, s48, 6144
  buffer_load_dwordx4 v[92:95], v9, s[24:27], s48 offen
  s_add_u32 s48, s48, 6144
  buffer_load_dwordx4 v[96:99], v9, s[24:27], s48 offen
  s_add_u32 s48, s48, 6144
  buffer_load_dwordx4 v[100:103], v9, s[24:27], s48 offen
  s_add_u32 s48, s48, 6144
  buffer_load_dwordx4 v[104:107], v9, s[24:27], s48 offen
  s_add_u32 s48, s48, 6144
  buffer_load_dwordx4 v[108:111], v9, s[24:27], s48 offen
  s_mov_b32 s52, 0x00100001
  s_mov_b32 s53, 0x10000100
  s_mov_b32 s54, 0x00200002
  s_mov_b32 s55, 0x20000200
  s_mov_b32 s56, 0x00400004
  s_mov_b32 s57, 0x40000400
  s_mov_b32 s58, 0x00800008
  s_mov_b32 s59, 0x80000800
  s_mov_b32 s60, 0x3b2aaaab
  s_mov_b32 s61, 0x3727c5ac
  v_mov_b32 v6, 0x3f803f80
  v_accvgpr_write_b32 a144, v6
  v_accvgpr_write_b32 a145, v6
  v_accvgpr_write_b32 a146, v6
  v_accvgpr_write_b32 a147, v6
  s_waitcnt lgkmcnt(0)
  s_add_u32 s94, s94, 1
  s_and_b32 s95, s94, 0xff
  v_mov_b32 v4, s95
  s_mul_i32 s48, s20, 3136
  v_add_u32 v6, s48, v216
  s_waitcnt vmcnt(14)
  ds_write_b128 v6, v[16:19] offset:0
  v_add_u32 v6, s48, v217
  s_waitcnt vmcnt(13)
  ds_write_b128 v6, v[20:23] offset:0
  v_add_u32 v6, s48, v218
  s_waitcnt vmcnt(12)
  ds_write_b128 v6, v[24:27] offset:0
  s_waitcnt lgkmcnt(0)
  s_barrier
  ds_read_b128 v[16:19], v5 offset:0
  ds_read_b128 v[20:23], v5 offset:64
  ds_read_b128 v[24:27], v5 offset:128
  ds_read_b128 v[28:31], v5 offset:192
  ds_read_b128 v[32:35], v5 offset:256
  ds_read_b128 v[36:39], v5 offset:320
  ds_read_b128 v[40:43], v5 offset:384
  ds_read_b128 v[44:47], v5 offset:448
  ds_read_b128 v[48:51], v5 offset:512
  ds_read_b128 v[52:55], v5 offset:576
  ds_read_b128 v[56:59], v5 offset:640
  ds_read_b128 v[60:63], v5 offset:704
  s_waitcnt lgkmcnt(11)
  v_mfma_f32_16x16x32_bf16 v[116:119], v[16:19], v[16:19], 0
  v_mfma_f32_16x16x32_bf16 v[112:115], a[144:147], v[16:19], 0
  s_waitcnt lgkmcnt(10)
  v_mfma_f32_16x16x32_bf16 v[116:119], v[20:23], v[20:23], v[116:119]
  v_mfma_f32_16x16x32_bf16 v[112:115], a[144:147], v[20:23], v[112:115]
  s_waitcnt lgkmcnt(9)
  v_mfma_f32_16x16x32_bf16 v[116:119], v[24:27], v[24:27], v[116:119]
  v_mfma_f32_16x16x32_bf16 v[112:115], a[144:147], v[24:27], v[112:115]
  s_waitcnt lgkmcnt(8)
  v_mfma_f32_16x16x32_bf16 v[116:119], v[28:31], v[28:31], v[116:119]
  v_mfma_f32_16x16x32_bf16 v[112:115], a[144:147], v[28:31], v[112:115]
  s_waitcnt lgkmcnt(7)
  v_mfma_f32_16x16x32_bf16 v[116:119], v[32:35], v[32:35], v[116:119]
  v_mfma_f32_16x16x32_bf16 v[112:115], a[144:147], v[32:35], v[112:115]
  s_waitcnt lgkmcnt(6)
  v_mfma_f32_16x16x32_bf16 v[116:119], v[36:39], v[36:39], v[116:119]
  v_mfma_f32_16x16x32_bf16 v[112:115], a[144:147], v[36:39], v[112:115]
  s_waitcnt lgkmcnt(5)
  v_mfma_f32_16x16x32_bf16 v[116:119], v[40:43], v[40:43], v[116:119]
  v_mfma_f32_16x16x32_bf16 v[112:115], a[144:147], v[40:43], v[112:115]
  s_waitcnt lgkmcnt(4)
  v_mfma_f32_16x16x32_bf16 v[116:119], v[44:47], v[44:47], v[116:119]
  v_mfma_f32_16x16x32_bf16 v[112:115], a[144:147], v[44:47], v[112:115]
  s_waitcnt lgkmcnt(3)
  v_mfma_f32_16x16x32_bf16 v[116:119], v[48:51], v[48:51], v[116:119]
  v_mfma_f32_16x16x32_bf16 v[112:115], a[144:147], v[48:51], v[112:115]
  s_waitcnt lgkmcnt(2)
  v_mfma_f32_16x16x32_bf16 v[116:119], v[52:55], v[52:55], v[116:119]
  v_mfma_f32_16x16x32_bf16 v[112:115], a[144:147], v[52:55], v[112:115]
  s_waitcnt lgkmcnt(1)
  v_mfma_f32_16x16x32_bf16 v[116:119], v[56:59], v[56:59], v[116:119]
  v_mfma_f32_16x16x32_bf16 v[112:115], a[144:147], v[56:59], v[112:115]
  s_waitcnt lgkmcnt(0)
  v_mfma_f32_16x16x32_bf16 v[116:119], v[60:63], v[60:63], v[116:119]
  v_mfma_f32_16x16x32_bf16 v[112:115], a[144:147], v[60:63], v[112:115]
  s_mul_i32 s48, s20, 13824
  v_add_u32 v10, s48, v10
  v_lshrrev_b32 v11, 2, v0
  v_and_b32 v11, 3, v11
  v_lshl_add_u32 v11, v3, 3, v11
  v_mul_u32_u24 v11, 144, v11
  v_and_b32 v13, 3, v0
  v_lshl_add_u32 v11, v13, 3, v11
  s_lshl_b32 s48, s20, 5
  v_add_u32 v11, s48, v11
  v_cndmask_b32 v12, 0, v116, s[52:53]
  v_cndmask_b32 v12, v12, v117, s[54:55]
  v_cndmask_b32 v12, v12, v118, s[56:57]
  v_cndmask_b32 v12, v12, v119, s[58:59]
  v_mul_f32 v14, s60, v112
  v_mov_b32 v13, v12
  s_nop 1
  v_permlane32_swap_b32 v12, v13
  v_add_f32 v12, v12, v13
  v_mov_b32 v13, v12
  s_nop 1
  v_permlane16_swap_b32 v12, v13
  v_add_f32 v12, v12, v13
  v_mov_b32 v13, s61
  v_fma_f32 v12, v12, s60, v13
  v_fma_f32 v12, -v14, v14, v12
  v_max_f32 v12, s61, v12
  v_rsq_f32 v15, v12
  s_waitcnt vmcnt(11)
  ds_write_b128 v10, v[64:67] offset:12544
  s_waitcnt vmcnt(10)
  ds_write_b128 v10, v[68:71] offset:13696
  s_waitcnt vmcnt(9)
  ds_write_b128 v10, v[72:75] offset:14848
  s_waitcnt vmcnt(8)
  ds_write_b128 v10, v[76:79] offset:16000
  s_waitcnt vmcnt(7)
  ds_write_b128 v10, v[80:83] offset:17152
  s_waitcnt vmcnt(6)
  ds_write_b128 v10, v[84:87] offset:18304
  s_waitcnt vmcnt(5)
  ds_write_b128 v10, v[88:91] offset:19456
  s_waitcnt vmcnt(4)
  ds_write_b128 v10, v[92:95] offset:20608
  s_waitcnt vmcnt(3)
  ds_write_b128 v10, v[96:99] offset:21760
  s_waitcnt vmcnt(2)
  ds_write_b128 v10, v[100:103] offset:22912
  s_waitcnt vmcnt(1)
  ds_write_b128 v10, v[104:107] offset:24064
  s_waitcnt vmcnt(0)
  ds_write_b128 v10, v[108:111] offset:25216
  s_waitcnt lgkmcnt(0)
  s_barrier
  ds_read_b64_tr_b16 a[0:1], v11 offset:12544
  ds_read_b64_tr_b16 a[2:3], v11 offset:13120
  ds_read_b64_tr_b16 a[4:5], v11 offset:17152
  ds_read_b64_tr_b16 a[6:7], v11 offset:17728
  ds_read_b64_tr_b16 a[8:9], v11 offset:21760
  ds_read_b64_tr_b16 a[10:11], v11 offset:22336
  ds_read_b64_tr_b16 a[12:13], v11 offset:26368
  ds_read_b64_tr_b16 a[14:15], v11 offset:26944
  ds_read_b64_tr_b16 a[16:17], v11 offset:30976
  ds_read_b64_tr_b16 a[18:19], v11 offset:31552
  ds_read_b64_tr_b16 a[20:21], v11 offset:35584
  ds_read_b64_tr_b16 a[22:23], v11 offset:36160
  ds_read_b64_tr_b16 a[24:25], v11 offset:40192
  ds_read_b64_tr_b16 a[26:27], v11 offset:40768
  ds_read_b64_tr_b16 a[28:29], v11 offset:44800
  ds_read_b64_tr_b16 a[30:31], v11 offset:45376
  ds_read_b64_tr_b16 a[32:33], v11 offset:49408
  ds_read_b64_tr_b16 a[34:35], v11 offset:49984
  ds_read_b64_tr_b16 a[36:37], v11 offset:54016
  ds_read_b64_tr_b16 a[38:39], v11 offset:54592
  ds_read_b64_tr_b16 a[40:41], v11 offset:58624
  ds_read_b64_tr_b16 a[42:43], v11 offset:59200
  ds_read_b64_tr_b16 a[44:45], v11 offset:63232
  ds_read_b64_tr_b16 a[46:47], v11 offset:63808
  v_mfma_f32_16x16x32_bf16 v[120:123], a[0:3], v[16:19], 0
  v_mfma_f32_16x16x32_bf16 v[124:127], a[0:3], a[144:147], 0
  v_mfma_f32_16x16x32_bf16 v[120:123], a[4:7], v[20:23], v[120:123]
  v_mfma_f32_16x16x32_bf16 v[124:127], a[4:7], a[144:147], v[124:127]
  v_mfma_f32_16x16x32_bf16 v[120:123], a[8:11], v[24:27], v[120:123]
  v_mfma_f32_16x16x32_bf16 v[124:127], a[8:11], a[144:147], v[124:127]
  v_mfma_f32_16x16x32_bf16 v[120:123], a[12:15], v[28:31], v[120:123]
  v_mfma_f32_16x16x32_bf16 v[124:127], a[12:15], a[144:147], v[124:127]
  s_waitcnt lgkmcnt(14)
  v_mfma_f32_16x16x32_bf16 v[120:123], a[16:19], v[32:35], v[120:123]
  v_mfma_f32_16x16x32_bf16 v[124:127], a[16:19], a[144:147], v[124:127]
  s_waitcnt lgkmcnt(12)
  v_mfma_f32_16x16x32_bf16 v[120:123], a[20:23], v[36:39], v[120:123]
  v_mfma_f32_16x16x32_bf16 v[124:127], a[20:23], a[144:147], v[124:127]
  s_waitcnt lgkmcnt(10)
  v_mfma_f32_16x16x32_bf16 v[120:123], a[24:27], v[40:43], v[120:123]
  v_mfma_f32_16x16x32_bf16 v[124:127], a[24:27], a[144:147], v[124:127]
  s_waitcnt lgkmcnt(8)
  v_mfma_f32_16x16x32_bf16 v[120:123], a[28:31], v[44:47], v[120:123]
  v_mfma_f32_16x16x32_bf16 v[124:127], a[28:31], a[144:147], v[124:127]
  s_waitcnt lgkmcnt(6)
  v_mfma_f32_16x16x32_bf16 v[120:123], a[32:35], v[48:51], v[120:123]
  v_mfma_f32_16x16x32_bf16 v[124:127], a[32:35], a[144:147], v[124:127]
  s_waitcnt lgkmcnt(4)
  v_mfma_f32_16x16x32_bf16 v[120:123], a[36:39], v[52:55], v[120:123]
  v_mfma_f32_16x16x32_bf16 v[124:127], a[36:39], a[144:147], v[124:127]
  s_waitcnt lgkmcnt(2)
  v_mfma_f32_16x16x32_bf16 v[120:123], a[40:43], v[56:59], v[120:123]
  v_mfma_f32_16x16x32_bf16 v[124:127], a[40:43], a[144:147], v[124:127]
  s_waitcnt lgkmcnt(0)
  v_mfma_f32_16x16x32_bf16 v[120:123], a[44:47], v[60:63], v[120:123]
  v_mfma_f32_16x16x32_bf16 v[124:127], a[44:47], a[144:147], v[124:127]
  s_nop 7
  v_fma_f32 v120, -v14, v124, v120
  v_fma_f32 v121, -v14, v125, v121
  v_fma_f32 v122, -v14, v126, v122
  v_fma_f32 v123, -v14, v127, v123
  v_mul_f32 v120, v120, v15
  v_mul_f32 v121, v121, v15
  v_mul_f32 v122, v122, v15
  v_mul_f32 v123, v123, v15
  v_bfi_b32 v120, s93, v4, v120
  v_bfi_b32 v121, s93, v4, v121
  v_bfi_b32 v122, s93, v4, v122
  v_bfi_b32 v123, s93, v4, v123
  s_lshl_b32 s48, s100, 2
  s_add_u32 s48, s48, s20
  s_lshl_b32 s48, s48, 10
  s_add_u32 s48, s48, 4096
  buffer_store_dwordx4 v[120:123], v1, s[16:19], s48 offen sc1
  s_branch standalone__detection_seg_dino__vision_kernel_sp_w
standalone__detection_seg_dino__vision_kernel_st2:
  s_sub_u32 s21, s100, 6
  s_lshl_b32 s21, s21, 2
  s_add_u32 s21, s21, s20
  s_mul_i32 s48, s21, 12288
  buffer_load_dwordx4 v[64:67], v1, s[28:31], s48 offen offset:0
  buffer_load_dwordx4 v[68:71], v1, s[28:31], s48 offen offset:1024
  buffer_load_dwordx4 v[72:75], v1, s[28:31], s48 offen offset:2048
  buffer_load_dwordx4 v[76:79], v1, s[28:31], s48 offen offset:3072
  s_add_u32 s48, s48, 4096
  buffer_load_dwordx4 v[80:83], v1, s[28:31], s48 offen offset:0
  buffer_load_dwordx4 v[84:87], v1, s[28:31], s48 offen offset:1024
  buffer_load_dwordx4 v[88:91], v1, s[28:31], s48 offen offset:2048
  buffer_load_dwordx4 v[92:95], v1, s[28:31], s48 offen offset:3072
  s_add_u32 s48, s48, 4096
  buffer_load_dwordx4 v[96:99], v1, s[28:31], s48 offen offset:0
  buffer_load_dwordx4 v[100:103], v1, s[28:31], s48 offen offset:1024
  buffer_load_dwordx4 v[104:107], v1, s[28:31], s48 offen offset:2048
  buffer_load_dwordx4 v[108:111], v1, s[28:31], s48 offen offset:3072
  s_mov_b32 s52, 0x00100001
  s_mov_b32 s53, 0x10000100
  s_mov_b32 s54, 0x00200002
  s_mov_b32 s55, 0x20000200
  s_mov_b32 s56, 0x00400004
  s_mov_b32 s57, 0x40000400
  s_mov_b32 s58, 0x00800008
  s_mov_b32 s59, 0x80000800
  s_mov_b32 s60, 0x3b2aaaab
  s_mov_b32 s61, 0x3727c5ac
  v_mov_b32 v6, 0x3f803f80
  v_accvgpr_write_b32 a144, v6
  v_accvgpr_write_b32 a145, v6
  v_accvgpr_write_b32 a146, v6
  v_accvgpr_write_b32 a147, v6
  s_waitcnt lgkmcnt(0)
  s_add_u32 s94, s94, 1
  s_and_b32 s95, s94, 0xff
  v_mov_b32 v4, s95
  s_mul_i32 s48, s20, 12544
  v_add_u32 v6, s48, v216
  s_waitcnt vmcnt(11)
  ds_write_b128 v6, v[64:67] offset:0
  v_add_u32 v6, s48, v217
  s_waitcnt vmcnt(10)
  ds_write_b128 v6, v[68:71] offset:0
  v_add_u32 v6, s48, v218
  s_waitcnt vmcnt(9)
  ds_write_b128 v6, v[72:75] offset:0
  v_add_u32 v6, s48, v219
  s_waitcnt vmcnt(8)
  ds_write_b128 v6, v[76:79] offset:0
  v_add_u32 v6, s48, v220
  s_waitcnt vmcnt(7)
  ds_write_b128 v6, v[80:83] offset:0
  v_add_u32 v6, s48, v221
  s_waitcnt vmcnt(6)
  ds_write_b128 v6, v[84:87] offset:0
  v_add_u32 v6, s48, v222
  s_waitcnt vmcnt(5)
  ds_write_b128 v6, v[88:91] offset:0
  v_add_u32 v6, s48, v223
  s_waitcnt vmcnt(4)
  ds_write_b128 v6, v[92:95] offset:0
  v_add_u32 v6, s48, v224
  s_waitcnt vmcnt(3)
  ds_write_b128 v6, v[96:99] offset:0
  v_add_u32 v6, s48, v225
  s_waitcnt vmcnt(2)
  ds_write_b128 v6, v[100:103] offset:0
  v_add_u32 v6, s48, v226
  s_waitcnt vmcnt(1)
  ds_write_b128 v6, v[104:107] offset:0
  v_add_u32 v6, s48, v227
  s_waitcnt vmcnt(0)
  ds_write_b128 v6, v[108:111] offset:0
  v_add_u32 v7, s48, v5
  ds_read_b128 a[48:51], v7 offset:0
  ds_read_b128 a[52:55], v7 offset:64
  ds_read_b128 a[56:59], v7 offset:128
  ds_read_b128 a[60:63], v7 offset:192
  ds_read_b128 a[64:67], v7 offset:256
  ds_read_b128 a[68:71], v7 offset:320
  ds_read_b128 a[72:75], v7 offset:384
  ds_read_b128 a[76:79], v7 offset:448
  ds_read_b128 a[80:83], v7 offset:512
  ds_read_b128 a[84:87], v7 offset:576
  ds_read_b128 a[88:91], v7 offset:640
  ds_read_b128 a[92:95], v7 offset:704
  s_mul_i32 s48, s20, 6144
  s_add_u32 s48, s48, 4096
  s_add_u32 s49, s48, 4096
  buffer_load_dwordx4 v[120:123], v1, s[16:19], s48 offen offset:0 sc1
  buffer_load_dwordx4 v[124:127], v1, s[16:19], s48 offen offset:1024 sc1
  buffer_load_dwordx4 v[128:131], v1, s[16:19], s48 offen offset:2048 sc1
  buffer_load_dwordx4 v[132:135], v1, s[16:19], s48 offen offset:3072 sc1
  buffer_load_dwordx4 v[136:139], v1, s[16:19], s49 offen offset:0 sc1
  buffer_load_dwordx4 v[140:143], v1, s[16:19], s49 offen offset:1024 sc1
  s_waitcnt vmcnt(5)
  v_xor_b32 v120, v120, v4
  v_xor_b32 v121, v121, v4
  v_xor_b32 v122, v122, v4
  v_xor_b32 v123, v123, v4
  s_waitcnt vmcnt(4)
  v_xor_b32 v124, v124, v4
  v_xor_b32 v125, v125, v4
  v_xor_b32 v126, v126, v4
  v_xor_b32 v127, v127, v4
  s_waitcnt vmcnt(3)
  v_xor_b32 v128, v128, v4
  v_xor_b32 v129, v129, v4
  v_xor_b32 v130, v130, v4
  v_xor_b32 v131, v131, v4
  s_waitcnt vmcnt(2)
  v_xor_b32 v132, v132, v4
  v_xor_b32 v133, v133, v4
  v_xor_b32 v134, v134, v4
  v_xor_b32 v135, v135, v4
  s_waitcnt vmcnt(1)
  v_xor_b32 v136, v136, v4
  v_xor_b32 v137, v137, v4
  v_xor_b32 v138, v138, v4
  v_xor_b32 v139, v139, v4
  s_waitcnt vmcnt(0)
  v_xor_b32 v140, v140, v4
  v_xor_b32 v141, v141, v4
  v_xor_b32 v142, v142, v4
  v_xor_b32 v143, v143, v4
  v_or_b32 v12, v120, v121
  v_or3_b32 v12, v12, v122, v123
  v_or3_b32 v12, v12, v124, v125
  v_or3_b32 v12, v12, v126, v127
  v_or3_b32 v12, v12, v128, v129
  v_or3_b32 v12, v12, v130, v131
  v_or3_b32 v12, v12, v132, v133
  v_or3_b32 v12, v12, v134, v135
  v_or3_b32 v12, v12, v136, v137
  v_or3_b32 v12, v12, v138, v139
  v_or3_b32 v12, v12, v140, v141
  v_or3_b32 v12, v12, v142, v143
  v_and_b32 v12, s93, v12
  v_cmp_ne_u32 vcc, 0, v12
  s_cbranch_vccz standalone__detection_seg_dino__vision_kernel_pl9_ok
  s_mov_b32 s92, 0
standalone__detection_seg_dino__vision_kernel_pl9_retry:
  s_mul_i32 s48, s20, 6144
  s_add_u32 s48, s48, 4096
  s_add_u32 s49, s48, 4096
  buffer_load_dwordx4 v[120:123], v1, s[16:19], s48 offen offset:0 sc1
  buffer_load_dwordx4 v[124:127], v1, s[16:19], s48 offen offset:1024 sc1
  buffer_load_dwordx4 v[128:131], v1, s[16:19], s48 offen offset:2048 sc1
  buffer_load_dwordx4 v[132:135], v1, s[16:19], s48 offen offset:3072 sc1
  buffer_load_dwordx4 v[136:139], v1, s[16:19], s49 offen offset:0 sc1
  buffer_load_dwordx4 v[140:143], v1, s[16:19], s49 offen offset:1024 sc1
  s_waitcnt vmcnt(0)
  v_xor_b32 v120, v120, v4
  v_xor_b32 v121, v121, v4
  v_xor_b32 v122, v122, v4
  v_xor_b32 v123, v123, v4
  v_xor_b32 v124, v124, v4
  v_xor_b32 v125, v125, v4
  v_xor_b32 v126, v126, v4
  v_xor_b32 v127, v127, v4
  v_xor_b32 v128, v128, v4
  v_xor_b32 v129, v129, v4
  v_xor_b32 v130, v130, v4
  v_xor_b32 v131, v131, v4
  v_xor_b32 v132, v132, v4
  v_xor_b32 v133, v133, v4
  v_xor_b32 v134, v134, v4
  v_xor_b32 v135, v135, v4
  v_xor_b32 v136, v136, v4
  v_xor_b32 v137, v137, v4
  v_xor_b32 v138, v138, v4
  v_xor_b32 v139, v139, v4
  v_xor_b32 v140, v140, v4
  v_xor_b32 v141, v141, v4
  v_xor_b32 v142, v142, v4
  v_xor_b32 v143, v143, v4
  v_or_b32 v12, v120, v121
  v_or3_b32 v12, v12, v122, v123
  v_or3_b32 v12, v12, v124, v125
  v_or3_b32 v12, v12, v126, v127
  v_or3_b32 v12, v12, v128, v129
  v_or3_b32 v12, v12, v130, v131
  v_or3_b32 v12, v12, v132, v133
  v_or3_b32 v12, v12, v134, v135
  v_or3_b32 v12, v12, v136, v137
  v_or3_b32 v12, v12, v138, v139
  v_or3_b32 v12, v12, v140, v141
  v_or3_b32 v12, v12, v142, v143
  v_and_b32 v12, s93, v12
  v_cmp_ne_u32 vcc, 0, v12
  s_waitcnt lgkmcnt(0)
  s_cbranch_vccz standalone__detection_seg_dino__vision_kernel_pl9_fin
  s_add_u32 s92, s92, 1
  s_cmp_lt_u32 s92, 1048576
  s_cbranch_scc1 standalone__detection_seg_dino__vision_kernel_pl9_retry
standalone__detection_seg_dino__vision_kernel_pl9_fin:
  s_nop 7
  s_nop 7
standalone__detection_seg_dino__vision_kernel_pl9_ok:
  v_lshrrev_b32 v7, 1, v3
  v_lshlrev_b32 v7, 8, v7
  v_lshl_add_u32 v7, v2, 4, v7
  v_and_b32 v8, 1, v3
  v_lshl_add_u32 v7, v8, 3, v7
  s_mul_i32 s48, s20, 3072
  v_add_u32 v7, s48, v7
  v_cvt_pk_bf16_f32 v120, v120, v121
  v_cvt_pk_bf16_f32 v121, v122, v123
  ds_write_b64 v7, v[120:121] offset:50176
  v_cvt_pk_bf16_f32 v124, v124, v125
  v_cvt_pk_bf16_f32 v125, v126, v127
  ds_write_b64 v7, v[124:125] offset:50688
  v_cvt_pk_bf16_f32 v128, v128, v129
  v_cvt_pk_bf16_f32 v129, v130, v131
  ds_write_b64 v7, v[128:129] offset:51200
  v_cvt_pk_bf16_f32 v132, v132, v133
  v_cvt_pk_bf16_f32 v133, v134, v135
  ds_write_b64 v7, v[132:133] offset:51712
  v_cvt_pk_bf16_f32 v136, v136, v137
  v_cvt_pk_bf16_f32 v137, v138, v139
  ds_write_b64 v7, v[136:137] offset:52224
  v_cvt_pk_bf16_f32 v140, v140, v141
  v_cvt_pk_bf16_f32 v141, v142, v143
  ds_write_b64 v7, v[140:141] offset:52736
  s_waitcnt lgkmcnt(0)
  s_barrier
  ds_read_b128 v[16:19], v1 offset:50176
  ds_read_b128 v[20:23], v1 offset:51200
  ds_read_b128 v[24:27], v1 offset:52224
  ds_read_b128 v[28:31], v1 offset:53248
  ds_read_b128 v[32:35], v1 offset:54272
  ds_read_b128 v[36:39], v1 offset:55296
  ds_read_b128 v[40:43], v1 offset:56320
  ds_read_b128 v[44:47], v1 offset:57344
  ds_read_b128 v[48:51], v1 offset:58368
  ds_read_b128 v[52:55], v1 offset:59392
  ds_read_b128 v[56:59], v1 offset:60416
  ds_read_b128 v[60:63], v1 offset:61440
  s_waitcnt lgkmcnt(11)
  v_mfma_f32_16x16x32_bf16 v[112:115], a[48:51], v[16:19], 0
  s_waitcnt lgkmcnt(10)
  v_mfma_f32_16x16x32_bf16 v[112:115], a[52:55], v[20:23], v[112:115]
  s_waitcnt lgkmcnt(9)
  v_mfma_f32_16x16x32_bf16 v[112:115], a[56:59], v[24:27], v[112:115]
  s_waitcnt lgkmcnt(8)
  v_mfma_f32_16x16x32_bf16 v[112:115], a[60:63], v[28:31], v[112:115]
  s_waitcnt lgkmcnt(7)
  v_mfma_f32_16x16x32_bf16 v[112:115], a[64:67], v[32:35], v[112:115]
  s_waitcnt lgkmcnt(6)
  v_mfma_f32_16x16x32_bf16 v[112:115], a[68:71], v[36:39], v[112:115]
  s_waitcnt lgkmcnt(5)
  v_mfma_f32_16x16x32_bf16 v[112:115], a[72:75], v[40:43], v[112:115]
  s_waitcnt lgkmcnt(4)
  v_mfma_f32_16x16x32_bf16 v[112:115], a[76:79], v[44:47], v[112:115]
  s_waitcnt lgkmcnt(3)
  v_mfma_f32_16x16x32_bf16 v[112:115], a[80:83], v[48:51], v[112:115]
  s_waitcnt lgkmcnt(2)
  v_mfma_f32_16x16x32_bf16 v[112:115], a[84:87], v[52:55], v[112:115]
  s_waitcnt lgkmcnt(1)
  v_mfma_f32_16x16x32_bf16 v[112:115], a[88:91], v[56:59], v[112:115]
  s_waitcnt lgkmcnt(0)
  v_mfma_f32_16x16x32_bf16 v[112:115], a[92:95], v[60:63], v[112:115]
  s_nop 7
  v_mul_f32 v112, 0x3d96c740, v112
  v_mul_f32 v113, 0x3d96c740, v113
  v_mul_f32 v114, 0x3d96c740, v114
  v_mul_f32 v115, 0x3d96c740, v115
  v_bfi_b32 v112, s93, v4, v112
  v_bfi_b32 v113, s93, v4, v113
  v_bfi_b32 v114, s93, v4, v114
  v_bfi_b32 v115, s93, v4, v115
  s_lshl_b32 s48, s21, 10
  s_add_u32 s48, s48, 28672
  buffer_store_dwordx4 v[112:115], v1, s[16:19], s48 offen sc1
standalone__detection_seg_dino__vision_kernel_sp_w:
  s_waitcnt lgkmcnt(0)
  s_nop 7
  s_nop 7
  s_barrier
  s_lshr_b32 s4, s95, 0
  s_and_b32 s48, s4, 2
  s_lshl_b32 s48, s48, 15
  s_and_b32 s4, s4, 1
  s_or_b32 s4, s4, s48
  s_lshr_b32 s5, s95, 2
  s_and_b32 s48, s5, 2
  s_lshl_b32 s48, s48, 15
  s_and_b32 s5, s5, 1
  s_or_b32 s5, s5, s48
  s_lshr_b32 s6, s95, 4
  s_and_b32 s48, s6, 2
  s_lshl_b32 s48, s48, 15
  s_and_b32 s6, s6, 1
  s_or_b32 s6, s6, s48
  s_lshr_b32 s7, s95, 6
  s_and_b32 s48, s7, 2
  s_lshl_b32 s48, s48, 15
  s_and_b32 s7, s7, 1
  s_or_b32 s7, s7, s48
  v_mov_b32 v12, s4
  v_mov_b32 v13, s5
  v_mov_b32 v14, s6
  v_mov_b32 v15, s7
  v_lshrrev_b32 v17, 2, v0
  v_lshlrev_b32 v17, 14, v17
  v_and_b32 v18, 3, v0
  v_lshl_add_u32 v17, v18, 4, v17
  s_mul_i32 s48, s20, 786432
  s_lshl_b32 s49, s2, 6
  s_add_u32 s48, s48, s49
  s_add_u32 s48, s48, 262144
  buffer_store_dwordx4 v[12:15], v17, s[16:19], s48 offen sc1
  s_add_u32 s48, s48, 262144
  buffer_store_dwordx4 v[12:15], v17, s[16:19], s48 offen sc1
  s_add_u32 s48, s48, 262144
  buffer_store_dwordx4 v[12:15], v17, s[16:19], s48 offen sc1
  v_mov_b32 v16, 0xf149f2ca
  v_mov_b32 v17, 0
  v_mov_b32 v18, 0
  v_mov_b32 v19, v4
  s_lshl_b32 s48, s2, 8
  s_lshl_b32 s49, s20, 6
  s_add_u32 s48, s48, s49
  s_add_u32 s48, s48, 77824
  s_mov_b64 exec, 0xf
  buffer_store_dwordx4 v[16:19], v1, s[16:19], s48 offen sc1
  s_nop 1
  v_bfi_b32 v17, s93, v4, v16
  v_lshrrev_b32 v18, 2, v1
  s_lshl_b32 s48, s20, 12
  s_lshl_b32 s49, s2, 4
  s_add_u32 s48, s48, s49
  s_add_u32 s48, s48, 143360
  buffer_store_dword v17, v18, s[16:19], s48 offen sc1
  s_mov_b64 exec, -1
  v_lshrrev_b32 v7, 2, v0
  v_and_b32 v8, 3, v0
  v_mul_u32_u24 v9, 768, v7
  v_lshl_add_u32 v9, v8, 4, v9
  v_mul_u32_u24 v10, 80, v7
  v_lshl_add_u32 v10, v8, 4, v10
  s_lshl_b32 s48, s100, 6
  s_mul_i32 s49, s20, 73728
  s_add_u32 s48, s48, s49
  buffer_load_dwordx4 v[20:23], v9, s[40:43], s48 offen
  s_add_u32 s48, s48, 12288
  buffer_load_dwordx4 v[24:27], v9, s[40:43], s48 offen
  s_add_u32 s48, s48, 12288
  buffer_load_dwordx4 v[28:31], v9, s[40:43], s48 offen
  s_add_u32 s48, s48, 12288
  buffer_load_dwordx4 v[32:35], v9, s[40:43], s48 offen
  s_add_u32 s48, s48, 12288
  buffer_load_dwordx4 v[36:39], v9, s[40:43], s48 offen
  s_add_u32 s48, s48, 12288
  buffer_load_dwordx4 v[40:43], v9, s[40:43], s48 offen
  s_mul_i32 s50, s20, 73728
  s_add_u32 s50, s50, 0
  buffer_load_dwordx4 v[64:67], v1, s[36:39], s50 offen offset:0
  buffer_load_dwordx4 v[68:71], v1, s[36:39], s50 offen offset:1024
  buffer_load_dwordx4 v[72:75], v1, s[36:39], s50 offen offset:2048
  buffer_load_dwordx4 v[76:79], v1, s[36:39], s50 offen offset:3072
  s_add_u32 s50, s50, 4096
  buffer_load_dwordx4 v[80:83], v1, s[36:39], s50 offen offset:0
  buffer_load_dwordx4 v[84:87], v1, s[36:39], s50 offen offset:1024
  buffer_load_dwordx4 v[88:91], v1, s[36:39], s50 offen offset:2048
  buffer_load_dwordx4 v[92:95], v1, s[36:39], s50 offen offset:3072
  s_add_u32 s50, s50, 4096
  buffer_load_dwordx4 v[96:99], v1, s[36:39], s50 offen offset:0
  buffer_load_dwordx4 v[100:103], v1, s[36:39], s50 offen offset:1024
  buffer_load_dwordx4 v[104:107], v1, s[36:39], s50 offen offset:2048
  buffer_load_dwordx4 v[108:111], v1, s[36:39], s50 offen offset:3072
  s_mul_i32 s50, s20, 73728
  s_add_u32 s50, s50, 12288
  buffer_load_dwordx4 v[112:115], v1, s[36:39], s50 offen offset:0
  buffer_load_dwordx4 v[116:119], v1, s[36:39], s50 offen offset:1024
  buffer_load_dwordx4 v[120:123], v1, s[36:39], s50 offen offset:2048
  buffer_load_dwordx4 v[124:127], v1, s[36:39], s50 offen offset:3072
  s_add_u32 s50, s50, 4096
  buffer_load_dwordx4 v[128:131], v1, s[36:39], s50 offen offset:0
  buffer_load_dwordx4 v[132:135], v1, s[36:39], s50 offen offset:1024
  buffer_load_dwordx4 v[136:139], v1, s[36:39], s50 offen offset:2048
  buffer_load_dwordx4 v[140:143], v1, s[36:39], s50 offen offset:3072
  s_add_u32 s50, s50, 4096
  buffer_load_dwordx4 v[144:147], v1, s[36:39], s50 offen offset:0
  buffer_load_dwordx4 v[148:151], v1, s[36:39], s50 offen offset:1024
  buffer_load_dwordx4 v[152:155], v1, s[36:39], s50 offen offset:2048
  buffer_load_dwordx4 v[156:159], v1, s[36:39], s50 offen offset:3072
  s_mul_i32 s49, s20, 7680
  v_add_u32 v10, s49, v10
  v_add_u32 v10, 100352, v10
  s_waitcnt vmcnt(29)
  ds_write_b128 v10, v[20:23] offset:0
  s_waitcnt vmcnt(28)
  ds_write_b128 v10, v[24:27] offset:1280
  s_waitcnt vmcnt(27)
  ds_write_b128 v10, v[28:31] offset:2560
  s_waitcnt vmcnt(26)
  ds_write_b128 v10, v[32:35] offset:3840
  s_waitcnt vmcnt(25)
  ds_write_b128 v10, v[36:39] offset:5120
  s_waitcnt vmcnt(24)
  ds_write_b128 v10, v[40:43] offset:6400
  s_waitcnt lgkmcnt(0)
  s_barrier
  v_lshrrev_b32 v10, 2, v0
  v_and_b32 v10, 3, v10
  v_lshl_add_u32 v10, v3, 3, v10
  v_mul_u32_u24 v10, 80, v10
  v_and_b32 v11, 3, v0
  v_lshl_add_u32 v10, v11, 3, v10
  v_add_u32 v10, 100352, v10
  ds_read_b64_tr_b16 a[0:1], v10 offset:0
  ds_read_b64_tr_b16 a[2:3], v10 offset:320
  ds_read_b64_tr_b16 a[4:5], v10 offset:2560
  ds_read_b64_tr_b16 a[6:7], v10 offset:2880
  ds_read_b64_tr_b16 a[8:9], v10 offset:5120
  ds_read_b64_tr_b16 a[10:11], v10 offset:5440
  ds_read_b64_tr_b16 a[12:13], v10 offset:7680
  ds_read_b64_tr_b16 a[14:15], v10 offset:8000
  ds_read_b64_tr_b16 a[16:17], v10 offset:10240
  ds_read_b64_tr_b16 a[18:19], v10 offset:10560
  ds_read_b64_tr_b16 a[20:21], v10 offset:12800
  ds_read_b64_tr_b16 a[22:23], v10 offset:13120
  ds_read_b64_tr_b16 a[24:25], v10 offset:15360
  ds_read_b64_tr_b16 a[26:27], v10 offset:15680
  ds_read_b64_tr_b16 a[28:29], v10 offset:17920
  ds_read_b64_tr_b16 a[30:31], v10 offset:18240
  ds_read_b64_tr_b16 a[32:33], v10 offset:20480
  ds_read_b64_tr_b16 a[34:35], v10 offset:20800
  ds_read_b64_tr_b16 a[36:37], v10 offset:23040
  ds_read_b64_tr_b16 a[38:39], v10 offset:23360
  ds_read_b64_tr_b16 a[40:41], v10 offset:25600
  ds_read_b64_tr_b16 a[42:43], v10 offset:25920
  ds_read_b64_tr_b16 a[44:45], v10 offset:28160
  ds_read_b64_tr_b16 a[46:47], v10 offset:28480
  ds_read_b64_tr_b16 a[48:49], v10 offset:32
  ds_read_b64_tr_b16 a[50:51], v10 offset:352
  ds_read_b64_tr_b16 a[52:53], v10 offset:2592
  ds_read_b64_tr_b16 a[54:55], v10 offset:2912
  ds_read_b64_tr_b16 a[56:57], v10 offset:5152
  ds_read_b64_tr_b16 a[58:59], v10 offset:5472
  ds_read_b64_tr_b16 a[60:61], v10 offset:7712
  ds_read_b64_tr_b16 a[62:63], v10 offset:8032
  ds_read_b64_tr_b16 a[64:65], v10 offset:10272
  ds_read_b64_tr_b16 a[66:67], v10 offset:10592
  ds_read_b64_tr_b16 a[68:69], v10 offset:12832
  ds_read_b64_tr_b16 a[70:71], v10 offset:13152
  ds_read_b64_tr_b16 a[72:73], v10 offset:15392
  ds_read_b64_tr_b16 a[74:75], v10 offset:15712
  ds_read_b64_tr_b16 a[76:77], v10 offset:17952
  ds_read_b64_tr_b16 a[78:79], v10 offset:18272
  ds_read_b64_tr_b16 a[80:81], v10 offset:20512
  ds_read_b64_tr_b16 a[82:83], v10 offset:20832
  ds_read_b64_tr_b16 a[84:85], v10 offset:23072
  ds_read_b64_tr_b16 a[86:87], v10 offset:23392
  ds_read_b64_tr_b16 a[88:89], v10 offset:25632
  ds_read_b64_tr_b16 a[90:91], v10 offset:25952
  ds_read_b64_tr_b16 a[92:93], v10 offset:28192
  ds_read_b64_tr_b16 a[94:95], v10 offset:28512
  s_mul_i32 s63, s20, 12544
  v_add_u32 v216, s63, v216
  v_add_u32 v217, s63, v217
  v_add_u32 v218, s63, v218
  v_add_u32 v219, s63, v219
  v_add_u32 v220, s63, v220
  v_add_u32 v221, s63, v221
  v_add_u32 v222, s63, v222
  v_add_u32 v223, s63, v223
  v_add_u32 v224, s63, v224
  v_add_u32 v225, s63, v225
  v_add_u32 v226, s63, v226
  v_add_u32 v227, s63, v227
  v_add_u32 v5, s63, v5
  s_waitcnt vmcnt(23)
  ds_write_b128 v216, v[64:67]
  s_waitcnt vmcnt(22)
  ds_write_b128 v217, v[68:71]
  s_waitcnt vmcnt(21)
  ds_write_b128 v218, v[72:75]
  s_waitcnt vmcnt(20)
  ds_write_b128 v219, v[76:79]
  s_waitcnt vmcnt(19)
  ds_write_b128 v220, v[80:83]
  s_waitcnt vmcnt(18)
  ds_write_b128 v221, v[84:87]
  s_waitcnt vmcnt(17)
  ds_write_b128 v222, v[88:91]
  s_waitcnt vmcnt(16)
  ds_write_b128 v223, v[92:95]
  s_waitcnt vmcnt(15)
  ds_write_b128 v224, v[96:99]
  s_waitcnt vmcnt(14)
  ds_write_b128 v225, v[100:103]
  s_waitcnt vmcnt(13)
  ds_write_b128 v226, v[104:107]
  s_waitcnt vmcnt(12)
  ds_write_b128 v227, v[108:111]
  s_mul_i32 s50, s20, 73728
  s_add_u32 s50, s50, 24576
  buffer_load_dwordx4 v[64:67], v1, s[36:39], s50 offen offset:0
  buffer_load_dwordx4 v[68:71], v1, s[36:39], s50 offen offset:1024
  buffer_load_dwordx4 v[72:75], v1, s[36:39], s50 offen offset:2048
  buffer_load_dwordx4 v[76:79], v1, s[36:39], s50 offen offset:3072
  s_add_u32 s50, s50, 4096
  buffer_load_dwordx4 v[80:83], v1, s[36:39], s50 offen offset:0
  buffer_load_dwordx4 v[84:87], v1, s[36:39], s50 offen offset:1024
  buffer_load_dwordx4 v[88:91], v1, s[36:39], s50 offen offset:2048
  buffer_load_dwordx4 v[92:95], v1, s[36:39], s50 offen offset:3072
  s_add_u32 s50, s50, 4096
  buffer_load_dwordx4 v[96:99], v1, s[36:39], s50 offen offset:0
  buffer_load_dwordx4 v[100:103], v1, s[36:39], s50 offen offset:1024
  buffer_load_dwordx4 v[104:107], v1, s[36:39], s50 offen offset:2048
  buffer_load_dwordx4 v[108:111], v1, s[36:39], s50 offen offset:3072
  ds_read_b128 a[96:99], v5 offset:0
  ds_read_b128 a[100:103], v5 offset:64
  ds_read_b128 a[104:107], v5 offset:128
  ds_read_b128 a[108:111], v5 offset:192
  ds_read_b128 a[112:115], v5 offset:256
  ds_read_b128 a[116:119], v5 offset:320
  ds_read_b128 a[120:123], v5 offset:384
  ds_read_b128 a[124:127], v5 offset:448
  ds_read_b128 a[128:131], v5 offset:512
  ds_read_b128 a[132:135], v5 offset:576
  ds_read_b128 a[136:139], v5 offset:640
  ds_read_b128 a[140:143], v5 offset:704
  s_waitcnt lgkmcnt(11)
  v_mfma_f32_16x16x32_bf16 v[20:23], a[96:99], a[0:3], 0
  v_mfma_f32_16x16x32_bf16 v[28:31], a[96:99], a[48:51], 0
  s_waitcnt lgkmcnt(10)
  v_mfma_f32_16x16x32_bf16 v[20:23], a[100:103], a[4:7], v[20:23]
  v_mfma_f32_16x16x32_bf16 v[28:31], a[100:103], a[52:55], v[28:31]
  s_waitcnt lgkmcnt(9)
  v_mfma_f32_16x16x32_bf16 v[20:23], a[104:107], a[8:11], v[20:23]
  v_mfma_f32_16x16x32_bf16 v[28:31], a[104:107], a[56:59], v[28:31]
  s_waitcnt lgkmcnt(8)
  v_mfma_f32_16x16x32_bf16 v[20:23], a[108:111], a[12:15], v[20:23]
  v_mfma_f32_16x16x32_bf16 v[28:31], a[108:111], a[60:63], v[28:31]
  s_waitcnt lgkmcnt(7)
  v_mfma_f32_16x16x32_bf16 v[20:23], a[112:115], a[16:19], v[20:23]
  v_mfma_f32_16x16x32_bf16 v[28:31], a[112:115], a[64:67], v[28:31]
  s_waitcnt lgkmcnt(6)
  v_mfma_f32_16x16x32_bf16 v[20:23], a[116:119], a[20:23], v[20:23]
  v_mfma_f32_16x16x32_bf16 v[28:31], a[116:119], a[68:71], v[28:31]
  s_waitcnt lgkmcnt(5)
  v_mfma_f32_16x16x32_bf16 v[20:23], a[120:123], a[24:27], v[20:23]
  v_mfma_f32_16x16x32_bf16 v[28:31], a[120:123], a[72:75], v[28:31]
  s_waitcnt lgkmcnt(4)
  v_mfma_f32_16x16x32_bf16 v[20:23], a[124:127], a[28:31], v[20:23]
  v_mfma_f32_16x16x32_bf16 v[28:31], a[124:127], a[76:79], v[28:31]
  s_waitcnt lgkmcnt(3)
  v_mfma_f32_16x16x32_bf16 v[20:23], a[128:131], a[32:35], v[20:23]
  v_mfma_f32_16x16x32_bf16 v[28:31], a[128:131], a[80:83], v[28:31]
  s_waitcnt lgkmcnt(2)
  v_mfma_f32_16x16x32_bf16 v[20:23], a[132:135], a[36:39], v[20:23]
  v_mfma_f32_16x16x32_bf16 v[28:31], a[132:135], a[84:87], v[28:31]
  s_waitcnt lgkmcnt(1)
  v_mfma_f32_16x16x32_bf16 v[20:23], a[136:139], a[40:43], v[20:23]
  v_mfma_f32_16x16x32_bf16 v[28:31], a[136:139], a[88:91], v[28:31]
  s_waitcnt lgkmcnt(0)
  v_mfma_f32_16x16x32_bf16 v[20:23], a[140:143], a[44:47], v[20:23]
  v_mfma_f32_16x16x32_bf16 v[28:31], a[140:143], a[92:95], v[28:31]
  s_waitcnt vmcnt(23)
  ds_write_b128 v216, v[112:115]
  s_waitcnt vmcnt(22)
  ds_write_b128 v217, v[116:119]
  s_waitcnt vmcnt(21)
  ds_write_b128 v218, v[120:123]
  s_waitcnt vmcnt(20)
  ds_write_b128 v219, v[124:127]
  s_waitcnt vmcnt(19)
  ds_write_b128 v220, v[128:131]
  s_waitcnt vmcnt(18)
  ds_write_b128 v221, v[132:135]
  s_waitcnt vmcnt(17)
  ds_write_b128 v222, v[136:139]
  s_waitcnt vmcnt(16)
  ds_write_b128 v223, v[140:143]
  s_waitcnt vmcnt(15)
  ds_write_b128 v224, v[144:147]
  s_waitcnt vmcnt(14)
  ds_write_b128 v225, v[148:151]
  s_waitcnt vmcnt(13)
  ds_write_b128 v226, v[152:155]
  s_waitcnt vmcnt(12)
  ds_write_b128 v227, v[156:159]
  s_mul_i32 s50, s20, 73728
  s_add_u32 s50, s50, 36864
  buffer_load_dwordx4 v[112:115], v1, s[36:39], s50 offen offset:0
  buffer_load_dwordx4 v[116:119], v1, s[36:39], s50 offen offset:1024
  buffer_load_dwordx4 v[120:123], v1, s[36:39], s50 offen offset:2048
  buffer_load_dwordx4 v[124:127], v1, s[36:39], s50 offen offset:3072
  s_add_u32 s50, s50, 4096
  buffer_load_dwordx4 v[128:131], v1, s[36:39], s50 offen offset:0
  buffer_load_dwordx4 v[132:135], v1, s[36:39], s50 offen offset:1024
  buffer_load_dwordx4 v[136:139], v1, s[36:39], s50 offen offset:2048
  buffer_load_dwordx4 v[140:143], v1, s[36:39], s50 offen offset:3072
  s_add_u32 s50, s50, 4096
  buffer_load_dwordx4 v[144:147], v1, s[36:39], s50 offen offset:0
  buffer_load_dwordx4 v[148:151], v1, s[36:39], s50 offen offset:1024
  buffer_load_dwordx4 v[152:155], v1, s[36:39], s50 offen offset:2048
  buffer_load_dwordx4 v[156:159], v1, s[36:39], s50 offen offset:3072
  ds_read_b128 a[96:99], v5 offset:0
  ds_read_b128 a[100:103], v5 offset:64
  ds_read_b128 a[104:107], v5 offset:128
  ds_read_b128 a[108:111], v5 offset:192
  ds_read_b128 a[112:115], v5 offset:256
  ds_read_b128 a[116:119], v5 offset:320
  ds_read_b128 a[120:123], v5 offset:384
  ds_read_b128 a[124:127], v5 offset:448
  ds_read_b128 a[128:131], v5 offset:512
  ds_read_b128 a[132:135], v5 offset:576
  ds_read_b128 a[136:139], v5 offset:640
  ds_read_b128 a[140:143], v5 offset:704
  s_waitcnt lgkmcnt(11)
  v_mfma_f32_16x16x32_bf16 v[24:27], a[96:99], a[0:3], 0
  v_mfma_f32_16x16x32_bf16 v[32:35], a[96:99], a[48:51], 0
  s_waitcnt lgkmcnt(10)
  v_mfma_f32_16x16x32_bf16 v[24:27], a[100:103], a[4:7], v[24:27]
  v_mfma_f32_16x16x32_bf16 v[32:35], a[100:103], a[52:55], v[32:35]
  s_waitcnt lgkmcnt(9)
  v_mfma_f32_16x16x32_bf16 v[24:27], a[104:107], a[8:11], v[24:27]
  v_mfma_f32_16x16x32_bf16 v[32:35], a[104:107], a[56:59], v[32:35]
  s_waitcnt lgkmcnt(8)
  v_mfma_f32_16x16x32_bf16 v[24:27], a[108:111], a[12:15], v[24:27]
  v_mfma_f32_16x16x32_bf16 v[32:35], a[108:111], a[60:63], v[32:35]
  s_waitcnt lgkmcnt(7)
  v_mfma_f32_16x16x32_bf16 v[24:27], a[112:115], a[16:19], v[24:27]
  v_mfma_f32_16x16x32_bf16 v[32:35], a[112:115], a[64:67], v[32:35]
  s_waitcnt lgkmcnt(6)
  v_mfma_f32_16x16x32_bf16 v[24:27], a[116:119], a[20:23], v[24:27]
  v_mfma_f32_16x16x32_bf16 v[32:35], a[116:119], a[68:71], v[32:35]
  s_waitcnt lgkmcnt(5)
  v_mfma_f32_16x16x32_bf16 v[24:27], a[120:123], a[24:27], v[24:27]
  v_mfma_f32_16x16x32_bf16 v[32:35], a[120:123], a[72:75], v[32:35]
  s_waitcnt lgkmcnt(4)
  v_mfma_f32_16x16x32_bf16 v[24:27], a[124:127], a[28:31], v[24:27]
  v_mfma_f32_16x16x32_bf16 v[32:35], a[124:127], a[76:79], v[32:35]
  s_waitcnt lgkmcnt(3)
  v_mfma_f32_16x16x32_bf16 v[24:27], a[128:131], a[32:35], v[24:27]
  v_mfma_f32_16x16x32_bf16 v[32:35], a[128:131], a[80:83], v[32:35]
  s_waitcnt lgkmcnt(2)
  v_mfma_f32_16x16x32_bf16 v[24:27], a[132:135], a[36:39], v[24:27]
  v_mfma_f32_16x16x32_bf16 v[32:35], a[132:135], a[84:87], v[32:35]
  s_waitcnt lgkmcnt(1)
  v_mfma_f32_16x16x32_bf16 v[24:27], a[136:139], a[40:43], v[24:27]
  v_mfma_f32_16x16x32_bf16 v[32:35], a[136:139], a[88:91], v[32:35]
  s_waitcnt lgkmcnt(0)
  v_mfma_f32_16x16x32_bf16 v[24:27], a[140:143], a[44:47], v[24:27]
  v_mfma_f32_16x16x32_bf16 v[32:35], a[140:143], a[92:95], v[32:35]
  v_cvt_pk_bf16_f32 v160, v20, v21
  v_cvt_pk_bf16_f32 v161, v22, v23
  s_nop 4
  v_cvt_pk_bf16_f32 v162, v24, v25
  v_cvt_pk_bf16_f32 v163, v26, v27
  v_cvt_pk_bf16_f32 v172, v28, v29
  v_cvt_pk_bf16_f32 v173, v30, v31
  v_cvt_pk_bf16_f32 v174, v32, v33
  v_cvt_pk_bf16_f32 v175, v34, v35
  s_waitcnt vmcnt(23)
  ds_write_b128 v216, v[64:67]
  s_waitcnt vmcnt(22)
  ds_write_b128 v217, v[68:71]
  s_waitcnt vmcnt(21)
  ds_write_b128 v218, v[72:75]
  s_waitcnt vmcnt(20)
  ds_write_b128 v219, v[76:79]
  s_waitcnt vmcnt(19)
  ds_write_b128 v220, v[80:83]
  s_waitcnt vmcnt(18)
  ds_write_b128 v221, v[84:87]
  s_waitcnt vmcnt(17)
  ds_write_b128 v222, v[88:91]
  s_waitcnt vmcnt(16)
  ds_write_b128 v223, v[92:95]
  s_waitcnt vmcnt(15)
  ds_write_b128 v224, v[96:99]
  s_waitcnt vmcnt(14)
  ds_write_b128 v225, v[100:103]
  s_waitcnt vmcnt(13)
  ds_write_b128 v226, v[104:107]
  s_waitcnt vmcnt(12)
  ds_write_b128 v227, v[108:111]
  s_mul_i32 s50, s20, 73728
  s_add_u32 s50, s50, 49152
  buffer_load_dwordx4 v[64:67], v1, s[36:39], s50 offen offset:0
  buffer_load_dwordx4 v[68:71], v1, s[36:39], s50 offen offset:1024
  buffer_load_dwordx4 v[72:75], v1, s[36:39], s50 offen offset:2048
  buffer_load_dwordx4 v[76:79], v1, s[36:39], s50 offen offset:3072
  s_add_u32 s50, s50, 4096
  buffer_load_dwordx4 v[80:83], v1, s[36:39], s50 offen offset:0
  buffer_load_dwordx4 v[84:87], v1, s[36:39], s50 offen offset:1024
  buffer_load_dwordx4 v[88:91], v1, s[36:39], s50 offen offset:2048
  buffer_load_dwordx4 v[92:95], v1, s[36:39], s50 offen offset:3072
  s_add_u32 s50, s50, 4096
  buffer_load_dwordx4 v[96:99], v1, s[36:39], s50 offen offset:0
  buffer_load_dwordx4 v[100:103], v1, s[36:39], s50 offen offset:1024
  buffer_load_dwordx4 v[104:107], v1, s[36:39], s50 offen offset:2048
  buffer_load_dwordx4 v[108:111], v1, s[36:39], s50 offen offset:3072
  ds_read_b128 a[96:99], v5 offset:0
  ds_read_b128 a[100:103], v5 offset:64
  ds_read_b128 a[104:107], v5 offset:128
  ds_read_b128 a[108:111], v5 offset:192
  ds_read_b128 a[112:115], v5 offset:256
  ds_read_b128 a[116:119], v5 offset:320
  ds_read_b128 a[120:123], v5 offset:384
  ds_read_b128 a[124:127], v5 offset:448
  ds_read_b128 a[128:131], v5 offset:512
  ds_read_b128 a[132:135], v5 offset:576
  ds_read_b128 a[136:139], v5 offset:640
  ds_read_b128 a[140:143], v5 offset:704
  s_waitcnt lgkmcnt(11)
  v_mfma_f32_16x16x32_bf16 v[20:23], a[96:99], a[0:3], 0
  v_mfma_f32_16x16x32_bf16 v[28:31], a[96:99], a[48:51], 0
  s_waitcnt lgkmcnt(10)
  v_mfma_f32_16x16x32_bf16 v[20:23], a[100:103], a[4:7], v[20:23]
  v_mfma_f32_16x16x32_bf16 v[28:31], a[100:103], a[52:55], v[28:31]
  s_waitcnt lgkmcnt(9)
  v_mfma_f32_16x16x32_bf16 v[20:23], a[104:107], a[8:11], v[20:23]
  v_mfma_f32_16x16x32_bf16 v[28:31], a[104:107], a[56:59], v[28:31]
  s_waitcnt lgkmcnt(8)
  v_mfma_f32_16x16x32_bf16 v[20:23], a[108:111], a[12:15], v[20:23]
  v_mfma_f32_16x16x32_bf16 v[28:31], a[108:111], a[60:63], v[28:31]
  s_waitcnt lgkmcnt(7)
  v_mfma_f32_16x16x32_bf16 v[20:23], a[112:115], a[16:19], v[20:23]
  v_mfma_f32_16x16x32_bf16 v[28:31], a[112:115], a[64:67], v[28:31]
  s_waitcnt lgkmcnt(6)
  v_mfma_f32_16x16x32_bf16 v[20:23], a[116:119], a[20:23], v[20:23]
  v_mfma_f32_16x16x32_bf16 v[28:31], a[116:119], a[68:71], v[28:31]
  s_waitcnt lgkmcnt(5)
  v_mfma_f32_16x16x32_bf16 v[20:23], a[120:123], a[24:27], v[20:23]
  v_mfma_f32_16x16x32_bf16 v[28:31], a[120:123], a[72:75], v[28:31]
  s_waitcnt lgkmcnt(4)
  v_mfma_f32_16x16x32_bf16 v[20:23], a[124:127], a[28:31], v[20:23]
  v_mfma_f32_16x16x32_bf16 v[28:31], a[124:127], a[76:79], v[28:31]
  s_waitcnt lgkmcnt(3)
  v_mfma_f32_16x16x32_bf16 v[20:23], a[128:131], a[32:35], v[20:23]
  v_mfma_f32_16x16x32_bf16 v[28:31], a[128:131], a[80:83], v[28:31]
  s_waitcnt lgkmcnt(2)
  v_mfma_f32_16x16x32_bf16 v[20:23], a[132:135], a[36:39], v[20:23]
  v_mfma_f32_16x16x32_bf16 v[28:31], a[132:135], a[84:87], v[28:31]
  s_waitcnt lgkmcnt(1)
  v_mfma_f32_16x16x32_bf16 v[20:23], a[136:139], a[40:43], v[20:23]
  v_mfma_f32_16x16x32_bf16 v[28:31], a[136:139], a[88:91], v[28:31]
  s_waitcnt lgkmcnt(0)
  v_mfma_f32_16x16x32_bf16 v[20:23], a[140:143], a[44:47], v[20:23]
  v_mfma_f32_16x16x32_bf16 v[28:31], a[140:143], a[92:95], v[28:31]
  s_waitcnt vmcnt(23)
  ds_write_b128 v216, v[112:115]
  s_waitcnt vmcnt(22)
  ds_write_b128 v217, v[116:119]
  s_waitcnt vmcnt(21)
  ds_write_b128 v218, v[120:123]
  s_waitcnt vmcnt(20)
  ds_write_b128 v219, v[124:127]
  s_waitcnt vmcnt(19)
  ds_write_b128 v220, v[128:131]
  s_waitcnt vmcnt(18)
  ds_write_b128 v221, v[132:135]
  s_waitcnt vmcnt(17)
  ds_write_b128 v222, v[136:139]
  s_waitcnt vmcnt(16)
  ds_write_b128 v223, v[140:143]
  s_waitcnt vmcnt(15)
  ds_write_b128 v224, v[144:147]
  s_waitcnt vmcnt(14)
  ds_write_b128 v225, v[148:151]
  s_waitcnt vmcnt(13)
  ds_write_b128 v226, v[152:155]
  s_waitcnt vmcnt(12)
  ds_write_b128 v227, v[156:159]
  s_mul_i32 s50, s20, 73728
  s_add_u32 s50, s50, 61440
  buffer_load_dwordx4 v[112:115], v1, s[36:39], s50 offen offset:0
  buffer_load_dwordx4 v[116:119], v1, s[36:39], s50 offen offset:1024
  buffer_load_dwordx4 v[120:123], v1, s[36:39], s50 offen offset:2048
  buffer_load_dwordx4 v[124:127], v1, s[36:39], s50 offen offset:3072
  s_add_u32 s50, s50, 4096
  buffer_load_dwordx4 v[128:131], v1, s[36:39], s50 offen offset:0
  buffer_load_dwordx4 v[132:135], v1, s[36:39], s50 offen offset:1024
  buffer_load_dwordx4 v[136:139], v1, s[36:39], s50 offen offset:2048
  buffer_load_dwordx4 v[140:143], v1, s[36:39], s50 offen offset:3072
  s_add_u32 s50, s50, 4096
  buffer_load_dwordx4 v[144:147], v1, s[36:39], s50 offen offset:0
  buffer_load_dwordx4 v[148:151], v1, s[36:39], s50 offen offset:1024
  buffer_load_dwordx4 v[152:155], v1, s[36:39], s50 offen offset:2048
  buffer_load_dwordx4 v[156:159], v1, s[36:39], s50 offen offset:3072
  ds_read_b128 a[96:99], v5 offset:0
  ds_read_b128 a[100:103], v5 offset:64
  ds_read_b128 a[104:107], v5 offset:128
  ds_read_b128 a[108:111], v5 offset:192
  ds_read_b128 a[112:115], v5 offset:256
  ds_read_b128 a[116:119], v5 offset:320
  ds_read_b128 a[120:123], v5 offset:384
  ds_read_b128 a[124:127], v5 offset:448
  ds_read_b128 a[128:131], v5 offset:512
  ds_read_b128 a[132:135], v5 offset:576
  ds_read_b128 a[136:139], v5 offset:640
  ds_read_b128 a[140:143], v5 offset:704
  s_waitcnt lgkmcnt(11)
  v_mfma_f32_16x16x32_bf16 v[24:27], a[96:99], a[0:3], 0
  v_mfma_f32_16x16x32_bf16 v[32:35], a[96:99], a[48:51], 0
  s_waitcnt lgkmcnt(10)
  v_mfma_f32_16x16x32_bf16 v[24:27], a[100:103], a[4:7], v[24:27]
  v_mfma_f32_16x16x32_bf16 v[32:35], a[100:103], a[52:55], v[32:35]
  s_waitcnt lgkmcnt(9)
  v_mfma_f32_16x16x32_bf16 v[24:27], a[104:107], a[8:11], v[24:27]
  v_mfma_f32_16x16x32_bf16 v[32:35], a[104:107], a[56:59], v[32:35]
  s_waitcnt lgkmcnt(8)
  v_mfma_f32_16x16x32_bf16 v[24:27], a[108:111], a[12:15], v[24:27]
  v_mfma_f32_16x16x32_bf16 v[32:35], a[108:111], a[60:63], v[32:35]
  s_waitcnt lgkmcnt(7)
  v_mfma_f32_16x16x32_bf16 v[24:27], a[112:115], a[16:19], v[24:27]
  v_mfma_f32_16x16x32_bf16 v[32:35], a[112:115], a[64:67], v[32:35]
  s_waitcnt lgkmcnt(6)
  v_mfma_f32_16x16x32_bf16 v[24:27], a[116:119], a[20:23], v[24:27]
  v_mfma_f32_16x16x32_bf16 v[32:35], a[116:119], a[68:71], v[32:35]
  s_waitcnt lgkmcnt(5)
  v_mfma_f32_16x16x32_bf16 v[24:27], a[120:123], a[24:27], v[24:27]
  v_mfma_f32_16x16x32_bf16 v[32:35], a[120:123], a[72:75], v[32:35]
  s_waitcnt lgkmcnt(4)
  v_mfma_f32_16x16x32_bf16 v[24:27], a[124:127], a[28:31], v[24:27]
  v_mfma_f32_16x16x32_bf16 v[32:35], a[124:127], a[76:79], v[32:35]
  s_waitcnt lgkmcnt(3)
  v_mfma_f32_16x16x32_bf16 v[24:27], a[128:131], a[32:35], v[24:27]
  v_mfma_f32_16x16x32_bf16 v[32:35], a[128:131], a[80:83], v[32:35]
  s_waitcnt lgkmcnt(2)
  v_mfma_f32_16x16x32_bf16 v[24:27], a[132:135], a[36:39], v[24:27]
  v_mfma_f32_16x16x32_bf16 v[32:35], a[132:135], a[84:87], v[32:35]
  s_waitcnt lgkmcnt(1)
  v_mfma_f32_16x16x32_bf16 v[24:27], a[136:139], a[40:43], v[24:27]
  v_mfma_f32_16x16x32_bf16 v[32:35], a[136:139], a[88:91], v[32:35]
  s_waitcnt lgkmcnt(0)
  v_mfma_f32_16x16x32_bf16 v[24:27], a[140:143], a[44:47], v[24:27]
  v_mfma_f32_16x16x32_bf16 v[32:35], a[140:143], a[92:95], v[32:35]
  v_cvt_pk_bf16_f32 v164, v20, v21
  v_cvt_pk_bf16_f32 v165, v22, v23
  s_nop 4
  v_cvt_pk_bf16_f32 v166, v24, v25
  v_cvt_pk_bf16_f32 v167, v26, v27
  v_cvt_pk_bf16_f32 v176, v28, v29
  v_cvt_pk_bf16_f32 v177, v30, v31
  v_cvt_pk_bf16_f32 v178, v32, v33
  v_cvt_pk_bf16_f32 v179, v34, v35
  s_waitcnt vmcnt(23)
  ds_write_b128 v216, v[64:67]
  s_waitcnt vmcnt(22)
  ds_write_b128 v217, v[68:71]
  s_waitcnt vmcnt(21)
  ds_write_b128 v218, v[72:75]
  s_waitcnt vmcnt(20)
  ds_write_b128 v219, v[76:79]
  s_waitcnt vmcnt(19)
  ds_write_b128 v220, v[80:83]
  s_waitcnt vmcnt(18)
  ds_write_b128 v221, v[84:87]
  s_waitcnt vmcnt(17)
  ds_write_b128 v222, v[88:91]
  s_waitcnt vmcnt(16)
  ds_write_b128 v223, v[92:95]
  s_waitcnt vmcnt(15)
  ds_write_b128 v224, v[96:99]
  s_waitcnt vmcnt(14)
  ds_write_b128 v225, v[100:103]
  s_waitcnt vmcnt(13)
  ds_write_b128 v226, v[104:107]
  s_waitcnt vmcnt(12)
  ds_write_b128 v227, v[108:111]
  ds_read_b128 a[96:99], v5 offset:0
  ds_read_b128 a[100:103], v5 offset:64
  ds_read_b128 a[104:107], v5 offset:128
  ds_read_b128 a[108:111], v5 offset:192
  ds_read_b128 a[112:115], v5 offset:256
  ds_read_b128 a[116:119], v5 offset:320
  ds_read_b128 a[120:123], v5 offset:384
  ds_read_b128 a[124:127], v5 offset:448
  ds_read_b128 a[128:131], v5 offset:512
  ds_read_b128 a[132:135], v5 offset:576
  ds_read_b128 a[136:139], v5 offset:640
  ds_read_b128 a[140:143], v5 offset:704
  s_waitcnt lgkmcnt(11)
  v_mfma_f32_16x16x32_bf16 v[20:23], a[96:99], a[0:3], 0
  v_mfma_f32_16x16x32_bf16 v[28:31], a[96:99], a[48:51], 0
  s_waitcnt lgkmcnt(10)
  v_mfma_f32_16x16x32_bf16 v[20:23], a[100:103], a[4:7], v[20:23]
  v_mfma_f32_16x16x32_bf16 v[28:31], a[100:103], a[52:55], v[28:31]
  s_waitcnt lgkmcnt(9)
  v_mfma_f32_16x16x32_bf16 v[20:23], a[104:107], a[8:11], v[20:23]
  v_mfma_f32_16x16x32_bf16 v[28:31], a[104:107], a[56:59], v[28:31]
  s_waitcnt lgkmcnt(8)
  v_mfma_f32_16x16x32_bf16 v[20:23], a[108:111], a[12:15], v[20:23]
  v_mfma_f32_16x16x32_bf16 v[28:31], a[108:111], a[60:63], v[28:31]
  s_waitcnt lgkmcnt(7)
  v_mfma_f32_16x16x32_bf16 v[20:23], a[112:115], a[16:19], v[20:23]
  v_mfma_f32_16x16x32_bf16 v[28:31], a[112:115], a[64:67], v[28:31]
  s_waitcnt lgkmcnt(6)
  v_mfma_f32_16x16x32_bf16 v[20:23], a[116:119], a[20:23], v[20:23]
  v_mfma_f32_16x16x32_bf16 v[28:31], a[116:119], a[68:71], v[28:31]
  s_waitcnt lgkmcnt(5)
  v_mfma_f32_16x16x32_bf16 v[20:23], a[120:123], a[24:27], v[20:23]
  v_mfma_f32_16x16x32_bf16 v[28:31], a[120:123], a[72:75], v[28:31]
  s_waitcnt lgkmcnt(4)
  v_mfma_f32_16x16x32_bf16 v[20:23], a[124:127], a[28:31], v[20:23]
  v_mfma_f32_16x16x32_bf16 v[28:31], a[124:127], a[76:79], v[28:31]
  s_waitcnt lgkmcnt(3)
  v_mfma_f32_16x16x32_bf16 v[20:23], a[128:131], a[32:35], v[20:23]
  v_mfma_f32_16x16x32_bf16 v[28:31], a[128:131], a[80:83], v[28:31]
  s_waitcnt lgkmcnt(2)
  v_mfma_f32_16x16x32_bf16 v[20:23], a[132:135], a[36:39], v[20:23]
  v_mfma_f32_16x16x32_bf16 v[28:31], a[132:135], a[84:87], v[28:31]
  s_waitcnt lgkmcnt(1)
  v_mfma_f32_16x16x32_bf16 v[20:23], a[136:139], a[40:43], v[20:23]
  v_mfma_f32_16x16x32_bf16 v[28:31], a[136:139], a[88:91], v[28:31]
  s_waitcnt lgkmcnt(0)
  v_mfma_f32_16x16x32_bf16 v[20:23], a[140:143], a[44:47], v[20:23]
  v_mfma_f32_16x16x32_bf16 v[28:31], a[140:143], a[92:95], v[28:31]
  s_waitcnt vmcnt(11)
  ds_write_b128 v216, v[112:115]
  s_waitcnt vmcnt(10)
  ds_write_b128 v217, v[116:119]
  s_waitcnt vmcnt(9)
  ds_write_b128 v218, v[120:123]
  s_waitcnt vmcnt(8)
  ds_write_b128 v219, v[124:127]
  s_waitcnt vmcnt(7)
  ds_write_b128 v220, v[128:131]
  s_waitcnt vmcnt(6)
  ds_write_b128 v221, v[132:135]
  s_waitcnt vmcnt(5)
  ds_write_b128 v222, v[136:139]
  s_waitcnt vmcnt(4)
  ds_write_b128 v223, v[140:143]
  s_waitcnt vmcnt(3)
  ds_write_b128 v224, v[144:147]
  s_waitcnt vmcnt(2)
  ds_write_b128 v225, v[148:151]
  s_waitcnt vmcnt(1)
  ds_write_b128 v226, v[152:155]
  s_waitcnt vmcnt(0)
  ds_write_b128 v227, v[156:159]
  ds_read_b128 a[96:99], v5 offset:0
  ds_read_b128 a[100:103], v5 offset:64
  ds_read_b128 a[104:107], v5 offset:128
  ds_read_b128 a[108:111], v5 offset:192
  ds_read_b128 a[112:115], v5 offset:256
  ds_read_b128 a[116:119], v5 offset:320
  ds_read_b128 a[120:123], v5 offset:384
  ds_read_b128 a[124:127], v5 offset:448
  ds_read_b128 a[128:131], v5 offset:512
  ds_read_b128 a[132:135], v5 offset:576
  ds_read_b128 a[136:139], v5 offset:640
  ds_read_b128 a[140:143], v5 offset:704
  s_waitcnt lgkmcnt(11)
  v_mfma_f32_16x16x32_bf16 v[24:27], a[96:99], a[0:3], 0
  v_mfma_f32_16x16x32_bf16 v[32:35], a[96:99], a[48:51], 0
  s_waitcnt lgkmcnt(10)
  v_mfma_f32_16x16x32_bf16 v[24:27], a[100:103], a[4:7], v[24:27]
  v_mfma_f32_16x16x32_bf16 v[32:35], a[100:103], a[52:55], v[32:35]
  s_waitcnt lgkmcnt(9)
  v_mfma_f32_16x16x32_bf16 v[24:27], a[104:107], a[8:11], v[24:27]
  v_mfma_f32_16x16x32_bf16 v[32:35], a[104:107], a[56:59], v[32:35]
  s_waitcnt lgkmcnt(8)
  v_mfma_f32_16x16x32_bf16 v[24:27], a[108:111], a[12:15], v[24:27]
  v_mfma_f32_16x16x32_bf16 v[32:35], a[108:111], a[60:63], v[32:35]
  s_waitcnt lgkmcnt(7)
  v_mfma_f32_16x16x32_bf16 v[24:27], a[112:115], a[16:19], v[24:27]
  v_mfma_f32_16x16x32_bf16 v[32:35], a[112:115], a[64:67], v[32:35]
  s_waitcnt lgkmcnt(6)
  v_mfma_f32_16x16x32_bf16 v[24:27], a[116:119], a[20:23], v[24:27]
  v_mfma_f32_16x16x32_bf16 v[32:35], a[116:119], a[68:71], v[32:35]
  s_waitcnt lgkmcnt(5)
  v_mfma_f32_16x16x32_bf16 v[24:27], a[120:123], a[24:27], v[24:27]
  v_mfma_f32_16x16x32_bf16 v[32:35], a[120:123], a[72:75], v[32:35]
  s_waitcnt lgkmcnt(4)
  v_mfma_f32_16x16x32_bf16 v[24:27], a[124:127], a[28:31], v[24:27]
  v_mfma_f32_16x16x32_bf16 v[32:35], a[124:127], a[76:79], v[32:35]
  s_waitcnt lgkmcnt(3)
  v_mfma_f32_16x16x32_bf16 v[24:27], a[128:131], a[32:35], v[24:27]
  v_mfma_f32_16x16x32_bf16 v[32:35], a[128:131], a[80:83], v[32:35]
  s_waitcnt lgkmcnt(2)
  v_mfma_f32_16x16x32_bf16 v[24:27], a[132:135], a[36:39], v[24:27]
  v_mfma_f32_16x16x32_bf16 v[32:35], a[132:135], a[84:87], v[32:35]
  s_waitcnt lgkmcnt(1)
  v_mfma_f32_16x16x32_bf16 v[24:27], a[136:139], a[40:43], v[24:27]
  v_mfma_f32_16x16x32_bf16 v[32:35], a[136:139], a[88:91], v[32:35]
  s_waitcnt lgkmcnt(0)
  v_mfma_f32_16x16x32_bf16 v[24:27], a[140:143], a[44:47], v[24:27]
  v_mfma_f32_16x16x32_bf16 v[32:35], a[140:143], a[92:95], v[32:35]
  v_cvt_pk_bf16_f32 v168, v20, v21
  v_cvt_pk_bf16_f32 v169, v22, v23
  s_nop 4
  v_cvt_pk_bf16_f32 v170, v24, v25
  v_cvt_pk_bf16_f32 v171, v26, v27
  v_cvt_pk_bf16_f32 v180, v28, v29
  v_cvt_pk_bf16_f32 v181, v30, v31
  v_cvt_pk_bf16_f32 v182, v32, v33
  v_cvt_pk_bf16_f32 v183, v34, v35
  v_mul_u32_u24 v7, 768, v2
  v_lshl_add_u32 v7, v3, 3, v7
  s_lshl_b32 s62, s100, 1
  s_and_b32 s48, s20, 1
  s_add_u32 s62, s62, s48
  s_lshl_b32 s62, s62, 5
  buffer_load_dwordx2 v[56:57], v7, s[32:35], s62 offen
  s_lshl_b32 s63, s20, 14
  s_add_u32 s63, s63, 77824
  s_mov_b32 s92, 0
  s_add_u32 s48, s63, 15360
standalone__detection_seg_dino__vision_kernel_fm_pre:
  buffer_load_dwordx4 v[64:67], v1, s[16:19], s48 offen sc1
  s_waitcnt vmcnt(0)
  v_xor_b32 v12, v67, v4
  v_and_b32 v12, s93, v12
  v_cmp_ne_u32 vcc, 0, v12
  s_cbranch_vccz standalone__detection_seg_dino__vision_kernel_fm_go
  s_sleep 6
  s_add_u32 s92, s92, 1
  s_cmp_lt_u32 s92, 1048576
  s_cbranch_scc1 standalone__detection_seg_dino__vision_kernel_fm_pre
standalone__detection_seg_dino__vision_kernel_fm_go:
  s_mov_b32 s50, 0xffff
  s_mov_b32 s92, 0
standalone__detection_seg_dino__vision_kernel_fm_loop:
  s_bitcmp0_b32 s50, 0
  s_cbranch_scc1 standalone__detection_seg_dino__vision_kernel_fm_a0
  s_add_u32 s48, s63, 0
  buffer_load_dwordx4 v[64:67], v1, s[16:19], s48 offen sc1
standalone__detection_seg_dino__vision_kernel_fm_a0:
  s_bitcmp0_b32 s50, 1
  s_cbranch_scc1 standalone__detection_seg_dino__vision_kernel_fm_a1
  s_add_u32 s48, s63, 1024
  buffer_load_dwordx4 v[68:71], v1, s[16:19], s48 offen sc1
standalone__detection_seg_dino__vision_kernel_fm_a1:
  s_bitcmp0_b32 s50, 2
  s_cbranch_scc1 standalone__detection_seg_dino__vision_kernel_fm_a2
  s_add_u32 s48, s63, 2048
  buffer_load_dwordx4 v[72:75], v1, s[16:19], s48 offen sc1
standalone__detection_seg_dino__vision_kernel_fm_a2:
  s_bitcmp0_b32 s50, 3
  s_cbranch_scc1 standalone__detection_seg_dino__vision_kernel_fm_a3
  s_add_u32 s48, s63, 3072
  buffer_load_dwordx4 v[76:79], v1, s[16:19], s48 offen sc1
standalone__detection_seg_dino__vision_kernel_fm_a3:
  s_bitcmp0_b32 s50, 4
  s_cbranch_scc1 standalone__detection_seg_dino__vision_kernel_fm_a4
  s_add_u32 s48, s63, 4096
  buffer_load_dwordx4 v[80:83], v1, s[16:19], s48 offen sc1
standalone__detection_seg_dino__vision_kernel_fm_a4:
  s_bitcmp0_b32 s50, 5
  s_cbranch_scc1 standalone__detection_seg_dino__vision_kernel_fm_a5
  s_add_u32 s48, s63, 5120
  buffer_load_dwordx4 v[84:87], v1, s[16:19], s48 offen sc1
standalone__detection_seg_dino__vision_kernel_fm_a5:
  s_bitcmp0_b32 s50, 6
  s_cbranch_scc1 standalone__detection_seg_dino__vision_kernel_fm_a6
  s_add_u32 s48, s63, 6144
  buffer_load_dwordx4 v[88:91], v1, s[16:19], s48 offen sc1
standalone__detection_seg_dino__vision_kernel_fm_a6:
  s_bitcmp0_b32 s50, 7
  s_cbranch_scc1 standalone__detection_seg_dino__vision_kernel_fm_a7
  s_add_u32 s48, s63, 7168
  buffer_load_dwordx4 v[92:95], v1, s[16:19], s48 offen sc1
standalone__detection_seg_dino__vision_kernel_fm_a7:
  s_bitcmp0_b32 s50, 8
  s_cbranch_scc1 standalone__detection_seg_dino__vision_kernel_fm_a8
  s_add_u32 s48, s63, 8192
  buffer_load_dwordx4 v[96:99], v1, s[16:19], s48 offen sc1
standalone__detection_seg_dino__vision_kernel_fm_a8:
  s_bitcmp0_b32 s50, 9
  s_cbranch_scc1 standalone__detection_seg_dino__vision_kernel_fm_a9
  s_add_u32 s48, s63, 9216
  buffer_load_dwordx4 v[100:103], v1, s[16:19], s48 offen sc1
standalone__detection_seg_dino__vision_kernel_fm_a9:
  s_bitcmp0_b32 s50, 10
  s_cbranch_scc1 standalone__detection_seg_dino__vision_kernel_fm_a10
  s_add_u32 s48, s63, 10240
  buffer_load_dwordx4 v[104:107], v1, s[16:19], s48 offen sc1
standalone__detection_seg_dino__vision_kernel_fm_a10:
  s_bitcmp0_b32 s50, 11
  s_cbranch_scc1 standalone__detection_seg_dino__vision_kernel_fm_a11
  s_add_u32 s48, s63, 11264
  buffer_load_dwordx4 v[108:111], v1, s[16:19], s48 offen sc1
standalone__detection_seg_dino__vision_kernel_fm_a11:
  s_bitcmp0_b32 s50, 12
  s_cbranch_scc1 standalone__detection_seg_dino__vision_kernel_fm_a12
  s_add_u32 s48, s63, 12288
  buffer_load_dwordx4 v[112:115], v1, s[16:19], s48 offen sc1
standalone__detection_seg_dino__vision_kernel_fm_a12:
  s_bitcmp0_b32 s50, 13
  s_cbranch_scc1 standalone__detection_seg_dino__vision_kernel_fm_a13
  s_add_u32 s48, s63, 13312
  buffer_load_dwordx4 v[116:119], v1, s[16:19], s48 offen sc1
standalone__detection_seg_dino__vision_kernel_fm_a13:
  s_bitcmp0_b32 s50, 14
  s_cbranch_scc1 standalone__detection_seg_dino__vision_kernel_fm_a14
  s_add_u32 s48, s63, 14336
  buffer_load_dwordx4 v[120:123], v1, s[16:19], s48 offen sc1
standalone__detection_seg_dino__vision_kernel_fm_a14:
  s_bitcmp0_b32 s50, 15
  s_cbranch_scc1 standalone__detection_seg_dino__vision_kernel_fm_a15
  s_add_u32 s48, s63, 15360
  buffer_load_dwordx4 v[124:127], v1, s[16:19], s48 offen sc1
standalone__detection_seg_dino__vision_kernel_fm_a15:
  s_waitcnt vmcnt(0)
  s_bitcmp0_b32 s50, 0
  s_cbranch_scc1 standalone__detection_seg_dino__vision_kernel_fm_c0
  v_xor_b32 v12, v67, v4
  v_and_b32 v12, s93, v12
  v_cmp_ne_u32 vcc, 0, v12
  s_cbranch_vccnz standalone__detection_seg_dino__vision_kernel_fm_c0
  s_bitset0_b32 s50, 0
standalone__detection_seg_dino__vision_kernel_fm_c0:
  s_bitcmp0_b32 s50, 1
  s_cbranch_scc1 standalone__detection_seg_dino__vision_kernel_fm_c1
  v_xor_b32 v12, v71, v4
  v_and_b32 v12, s93, v12
  v_cmp_ne_u32 vcc, 0, v12
  s_cbranch_vccnz standalone__detection_seg_dino__vision_kernel_fm_c1
  s_bitset0_b32 s50, 1
standalone__detection_seg_dino__vision_kernel_fm_c1:
  s_bitcmp0_b32 s50, 2
  s_cbranch_scc1 standalone__detection_seg_dino__vision_kernel_fm_c2
  v_xor_b32 v12, v75, v4
  v_and_b32 v12, s93, v12
  v_cmp_ne_u32 vcc, 0, v12
  s_cbranch_vccnz standalone__detection_seg_dino__vision_kernel_fm_c2
  s_bitset0_b32 s50, 2
standalone__detection_seg_dino__vision_kernel_fm_c2:
  s_bitcmp0_b32 s50, 3
  s_cbranch_scc1 standalone__detection_seg_dino__vision_kernel_fm_c3
  v_xor_b32 v12, v79, v4
  v_and_b32 v12, s93, v12
  v_cmp_ne_u32 vcc, 0, v12
  s_cbranch_vccnz standalone__detection_seg_dino__vision_kernel_fm_c3
  s_bitset0_b32 s50, 3
standalone__detection_seg_dino__vision_kernel_fm_c3:
  s_bitcmp0_b32 s50, 4
  s_cbranch_scc1 standalone__detection_seg_dino__vision_kernel_fm_c4
  v_xor_b32 v12, v83, v4
  v_and_b32 v12, s93, v12
  v_cmp_ne_u32 vcc, 0, v12
  s_cbranch_vccnz standalone__detection_seg_dino__vision_kernel_fm_c4
  s_bitset0_b32 s50, 4
standalone__detection_seg_dino__vision_kernel_fm_c4:
  s_bitcmp0_b32 s50, 5
  s_cbranch_scc1 standalone__detection_seg_dino__vision_kernel_fm_c5
  v_xor_b32 v12, v87, v4
  v_and_b32 v12, s93, v12
  v_cmp_ne_u32 vcc, 0, v12
  s_cbranch_vccnz standalone__detection_seg_dino__vision_kernel_fm_c5
  s_bitset0_b32 s50, 5
standalone__detection_seg_dino__vision_kernel_fm_c5:
  s_bitcmp0_b32 s50, 6
  s_cbranch_scc1 standalone__detection_seg_dino__vision_kernel_fm_c6
  v_xor_b32 v12, v91, v4
  v_and_b32 v12, s93, v12
  v_cmp_ne_u32 vcc, 0, v12
  s_cbranch_vccnz standalone__detection_seg_dino__vision_kernel_fm_c6
  s_bitset0_b32 s50, 6
standalone__detection_seg_dino__vision_kernel_fm_c6:
  s_bitcmp0_b32 s50, 7
  s_cbranch_scc1 standalone__detection_seg_dino__vision_kernel_fm_c7
  v_xor_b32 v12, v95, v4
  v_and_b32 v12, s93, v12
  v_cmp_ne_u32 vcc, 0, v12
  s_cbranch_vccnz standalone__detection_seg_dino__vision_kernel_fm_c7
  s_bitset0_b32 s50, 7
standalone__detection_seg_dino__vision_kernel_fm_c7:
  s_bitcmp0_b32 s50, 8
  s_cbranch_scc1 standalone__detection_seg_dino__vision_kernel_fm_c8
  v_xor_b32 v12, v99, v4
  v_and_b32 v12, s93, v12
  v_cmp_ne_u32 vcc, 0, v12
  s_cbranch_vccnz standalone__detection_seg_dino__vision_kernel_fm_c8
  s_bitset0_b32 s50, 8
standalone__detection_seg_dino__vision_kernel_fm_c8:
  s_bitcmp0_b32 s50, 9
  s_cbranch_scc1 standalone__detection_seg_dino__vision_kernel_fm_c9
  v_xor_b32 v12, v103, v4
  v_and_b32 v12, s93, v12
  v_cmp_ne_u32 vcc, 0, v12
  s_cbranch_vccnz standalone__detection_seg_dino__vision_kernel_fm_c9
  s_bitset0_b32 s50, 9
standalone__detection_seg_dino__vision_kernel_fm_c9:
  s_bitcmp0_b32 s50, 10
  s_cbranch_scc1 standalone__detection_seg_dino__vision_kernel_fm_c10
  v_xor_b32 v12, v107, v4
  v_and_b32 v12, s93, v12
  v_cmp_ne_u32 vcc, 0, v12
  s_cbranch_vccnz standalone__detection_seg_dino__vision_kernel_fm_c10
  s_bitset0_b32 s50, 10
standalone__detection_seg_dino__vision_kernel_fm_c10:
  s_bitcmp0_b32 s50, 11
  s_cbranch_scc1 standalone__detection_seg_dino__vision_kernel_fm_c11
  v_xor_b32 v12, v111, v4
  v_and_b32 v12, s93, v12
  v_cmp_ne_u32 vcc, 0, v12
  s_cbranch_vccnz standalone__detection_seg_dino__vision_kernel_fm_c11
  s_bitset0_b32 s50, 11
standalone__detection_seg_dino__vision_kernel_fm_c11:
  s_bitcmp0_b32 s50, 12
  s_cbranch_scc1 standalone__detection_seg_dino__vision_kernel_fm_c12
  v_xor_b32 v12, v115, v4
  v_and_b32 v12, s93, v12
  v_cmp_ne_u32 vcc, 0, v12
  s_cbranch_vccnz standalone__detection_seg_dino__vision_kernel_fm_c12
  s_bitset0_b32 s50, 12
standalone__detection_seg_dino__vision_kernel_fm_c12:
  s_bitcmp0_b32 s50, 13
  s_cbranch_scc1 standalone__detection_seg_dino__vision_kernel_fm_c13
  v_xor_b32 v12, v119, v4
  v_and_b32 v12, s93, v12
  v_cmp_ne_u32 vcc, 0, v12
  s_cbranch_vccnz standalone__detection_seg_dino__vision_kernel_fm_c13
  s_bitset0_b32 s50, 13
standalone__detection_seg_dino__vision_kernel_fm_c13:
  s_bitcmp0_b32 s50, 14
  s_cbranch_scc1 standalone__detection_seg_dino__vision_kernel_fm_c14
  v_xor_b32 v12, v123, v4
  v_and_b32 v12, s93, v12
  v_cmp_ne_u32 vcc, 0, v12
  s_cbranch_vccnz standalone__detection_seg_dino__vision_kernel_fm_c14
  s_bitset0_b32 s50, 14
standalone__detection_seg_dino__vision_kernel_fm_c14:
  s_bitcmp0_b32 s50, 15
  s_cbranch_scc1 standalone__detection_seg_dino__vision_kernel_fm_c15
  v_xor_b32 v12, v127, v4
  v_and_b32 v12, s93, v12
  v_cmp_ne_u32 vcc, 0, v12
  s_cbranch_vccnz standalone__detection_seg_dino__vision_kernel_fm_c15
  s_bitset0_b32 s50, 15
standalone__detection_seg_dino__vision_kernel_fm_c15:
  s_cmp_eq_u32 s50, 0
  s_cbranch_scc1 standalone__detection_seg_dino__vision_kernel_fm_done
  s_add_u32 s92, s92, 1
  s_cmp_lt_u32 s92, 1048576
  s_cbranch_scc1 standalone__detection_seg_dino__vision_kernel_fm_loop
standalone__detection_seg_dino__vision_kernel_fm_done:
  s_nop 7
  v_max3_f32 v8, v64, v68, v72
  v_max3_f32 v8, v8, v76, v80
  v_max3_f32 v8, v8, v84, v88
  v_max3_f32 v8, v8, v92, v96
  v_max3_f32 v8, v8, v100, v104
  v_max3_f32 v8, v8, v108, v112
  v_max3_f32 v8, v8, v116, v120
  v_max_f32 v8, v8, v124
  v_mov_b32 v9, v8
  s_nop 1
  v_permlane32_swap_b32 v8, v9
  v_max_f32 v8, v8, v9
  v_mov_b32 v9, v8
  s_nop 1
  v_permlane16_swap_b32 v8, v9
  v_max_f32 v8, v8, v9
  v_sub_f32 v64, v64, v8
  v_sub_f32 v68, v68, v8
  v_sub_f32 v72, v72, v8
  v_sub_f32 v76, v76, v8
  v_sub_f32 v80, v80, v8
  v_sub_f32 v84, v84, v8
  v_sub_f32 v88, v88, v8
  v_sub_f32 v92, v92, v8
  v_sub_f32 v96, v96, v8
  v_sub_f32 v100, v100, v8
  v_sub_f32 v104, v104, v8
  v_sub_f32 v108, v108, v8
  v_sub_f32 v112, v112, v8
  v_sub_f32 v116, v116, v8
  v_sub_f32 v120, v120, v8
  v_sub_f32 v124, v124, v8
  v_exp_f32 v64, v64
  v_exp_f32 v68, v68
  v_exp_f32 v72, v72
  v_exp_f32 v76, v76
  v_exp_f32 v80, v80
  v_exp_f32 v84, v84
  v_exp_f32 v88, v88
  v_exp_f32 v92, v92
  v_exp_f32 v96, v96
  v_exp_f32 v100, v100
  v_exp_f32 v104, v104
  v_exp_f32 v108, v108
  v_exp_f32 v112, v112
  v_exp_f32 v116, v116
  v_exp_f32 v120, v120
  v_exp_f32 v124, v124
  v_mul_f32 v13, v64, v65
  v_fma_f32 v13, v68, v69, v13
  v_fma_f32 v13, v72, v73, v13
  v_fma_f32 v13, v76, v77, v13
  v_fma_f32 v13, v80, v81, v13
  v_fma_f32 v13, v84, v85, v13
  v_fma_f32 v13, v88, v89, v13
  v_fma_f32 v13, v92, v93, v13
  v_fma_f32 v13, v96, v97, v13
  v_fma_f32 v13, v100, v101, v13
  v_fma_f32 v13, v104, v105, v13
  v_fma_f32 v13, v108, v109, v13
  v_fma_f32 v13, v112, v113, v13
  v_fma_f32 v13, v116, v117, v13
  v_fma_f32 v13, v120, v121, v13
  v_fma_f32 v13, v124, v125, v13
  v_mov_b32 v9, v13
  s_nop 1
  v_permlane32_swap_b32 v13, v9
  v_add_f32 v13, v13, v9
  v_mov_b32 v9, v13
  s_nop 1
  v_permlane16_swap_b32 v13, v9
  v_add_f32 v13, v13, v9
  v_mov_b32 v14, 0
  v_mov_b32 v12, v8
  v_mov_b32 v15, 0
  s_barrier
  v_lshlrev_b32 v9, 6, v2
  s_lshl_b32 s48, s20, 4
  v_add_u32 v8, s48, v9
  ds_write_b128 v8, v[12:15] offset:0
  s_waitcnt lgkmcnt(0)
  s_barrier
  ds_read_b128 v[64:67], v9 offset:0
  ds_read_b128 v[68:71], v9 offset:16
  ds_read_b128 v[72:75], v9 offset:32
  ds_read_b128 v[76:79], v9 offset:48
  s_waitcnt lgkmcnt(1)
  v_max3_f32 v8, v64, v68, v72
  s_waitcnt lgkmcnt(0)
  v_max_f32 v8, v8, v76
  v_sub_f32 v64, v64, v8
  v_sub_f32 v68, v68, v8
  v_sub_f32 v72, v72, v8
  v_sub_f32 v76, v76, v8
  v_exp_f32 v64, v64
  v_exp_f32 v68, v68
  v_exp_f32 v72, v72
  v_exp_f32 v76, v76
  v_mul_f32 v13, v64, v65
  v_fma_f32 v13, v68, v69, v13
  v_fma_f32 v13, v72, v73, v13
  v_fma_f32 v13, v76, v77, v13
  v_rcp_f32 v13, v13
  v_lshlrev_b32 v10, 1, v1
  s_mul_i32 s48, s20, 6144
  s_add_u32 s48, s48, 53248
  s_add_u32 s49, s48, 4096
  buffer_load_dwordx4 v[64:67], v10, s[16:19], s48 offen offset:0 sc1
  buffer_load_dwordx4 v[68:71], v10, s[16:19], s48 offen offset:16 sc1
  buffer_load_dwordx4 v[72:75], v10, s[16:19], s48 offen offset:2048 sc1
  buffer_load_dwordx4 v[76:79], v10, s[16:19], s48 offen offset:2064 sc1
  buffer_load_dwordx4 v[80:83], v10, s[16:19], s49 offen offset:0 sc1
  buffer_load_dwordx4 v[84:87], v10, s[16:19], s49 offen offset:16 sc1
  s_waitcnt vmcnt(5)
  v_xor_b32 v64, v64, v4
  v_xor_b32 v65, v65, v4
  v_xor_b32 v66, v66, v4
  v_xor_b32 v67, v67, v4
  s_waitcnt vmcnt(4)
  v_xor_b32 v68, v68, v4
  v_xor_b32 v69, v69, v4
  v_xor_b32 v70, v70, v4
  v_xor_b32 v71, v71, v4
  s_waitcnt vmcnt(3)
  v_xor_b32 v72, v72, v4
  v_xor_b32 v73, v73, v4
  v_xor_b32 v74, v74, v4
  v_xor_b32 v75, v75, v4
  s_waitcnt vmcnt(2)
  v_xor_b32 v76, v76, v4
  v_xor_b32 v77, v77, v4
  v_xor_b32 v78, v78, v4
  v_xor_b32 v79, v79, v4
  s_waitcnt vmcnt(1)
  v_xor_b32 v80, v80, v4
  v_xor_b32 v81, v81, v4
  v_xor_b32 v82, v82, v4
  v_xor_b32 v83, v83, v4
  s_waitcnt vmcnt(0)
  v_xor_b32 v84, v84, v4
  v_xor_b32 v85, v85, v4
  v_xor_b32 v86, v86, v4
  v_xor_b32 v87, v87, v4
  v_or_b32 v12, v64, v65
  v_or3_b32 v12, v12, v66, v67
  v_or3_b32 v12, v12, v68, v69
  v_or3_b32 v12, v12, v70, v71
  v_or3_b32 v12, v12, v72, v73
  v_or3_b32 v12, v12, v74, v75
  v_or3_b32 v12, v12, v76, v77
  v_or3_b32 v12, v12, v78, v79
  v_or3_b32 v12, v12, v80, v81
  v_or3_b32 v12, v12, v82, v83
  v_or3_b32 v12, v12, v84, v85
  v_or3_b32 v12, v12, v86, v87
  v_and_b32 v12, s93, v12
  v_cmp_ne_u32 vcc, 0, v12
  s_cbranch_vccz standalone__detection_seg_dino__vision_kernel_pl10_ok
  s_mov_b32 s92, 0
standalone__detection_seg_dino__vision_kernel_pl10_retry:
  s_mul_i32 s48, s20, 6144
  s_add_u32 s48, s48, 53248
  s_add_u32 s49, s48, 4096
  buffer_load_dwordx4 v[64:67], v10, s[16:19], s48 offen offset:0 sc1
  buffer_load_dwordx4 v[68:71], v10, s[16:19], s48 offen offset:16 sc1
  buffer_load_dwordx4 v[72:75], v10, s[16:19], s48 offen offset:2048 sc1
  buffer_load_dwordx4 v[76:79], v10, s[16:19], s48 offen offset:2064 sc1
  buffer_load_dwordx4 v[80:83], v10, s[16:19], s49 offen offset:0 sc1
  buffer_load_dwordx4 v[84:87], v10, s[16:19], s49 offen offset:16 sc1
  s_waitcnt vmcnt(0)
  v_xor_b32 v64, v64, v4
  v_xor_b32 v65, v65, v4
  v_xor_b32 v66, v66, v4
  v_xor_b32 v67, v67, v4
  v_xor_b32 v68, v68, v4
  v_xor_b32 v69, v69, v4
  v_xor_b32 v70, v70, v4
  v_xor_b32 v71, v71, v4
  v_xor_b32 v72, v72, v4
  v_xor_b32 v73, v73, v4
  v_xor_b32 v74, v74, v4
  v_xor_b32 v75, v75, v4
  v_xor_b32 v76, v76, v4
  v_xor_b32 v77, v77, v4
  v_xor_b32 v78, v78, v4
  v_xor_b32 v79, v79, v4
  v_xor_b32 v80, v80, v4
  v_xor_b32 v81, v81, v4
  v_xor_b32 v82, v82, v4
  v_xor_b32 v83, v83, v4
  v_xor_b32 v84, v84, v4
  v_xor_b32 v85, v85, v4
  v_xor_b32 v86, v86, v4
  v_xor_b32 v87, v87, v4
  v_or_b32 v12, v64, v65
  v_or3_b32 v12, v12, v66, v67
  v_or3_b32 v12, v12, v68, v69
  v_or3_b32 v12, v12, v70, v71
  v_or3_b32 v12, v12, v72, v73
  v_or3_b32 v12, v12, v74, v75
  v_or3_b32 v12, v12, v76, v77
  v_or3_b32 v12, v12, v78, v79
  v_or3_b32 v12, v12, v80, v81
  v_or3_b32 v12, v12, v82, v83
  v_or3_b32 v12, v12, v84, v85
  v_or3_b32 v12, v12, v86, v87
  v_and_b32 v12, s93, v12
  v_cmp_ne_u32 vcc, 0, v12
  s_cbranch_vccz standalone__detection_seg_dino__vision_kernel_pl10_fin
  s_add_u32 s92, s92, 1
  s_cmp_lt_u32 s92, 1048576
  s_cbranch_scc1 standalone__detection_seg_dino__vision_kernel_pl10_retry
standalone__detection_seg_dino__vision_kernel_pl10_fin:
  s_nop 7
  s_nop 7
standalone__detection_seg_dino__vision_kernel_pl10_ok:
  v_cvt_pk_bf16_f32 v96, v64, v65
  v_cvt_pk_bf16_f32 v97, v66, v67
  v_cvt_pk_bf16_f32 v98, v68, v69
  v_cvt_pk_bf16_f32 v99, v70, v71
  v_cvt_pk_bf16_f32 v100, v72, v73
  v_cvt_pk_bf16_f32 v101, v74, v75
  v_cvt_pk_bf16_f32 v102, v76, v77
  v_cvt_pk_bf16_f32 v103, v78, v79
  v_cvt_pk_bf16_f32 v104, v80, v81
  v_cvt_pk_bf16_f32 v105, v82, v83
  v_cvt_pk_bf16_f32 v106, v84, v85
  v_cvt_pk_bf16_f32 v107, v86, v87
  v_mfma_f32_16x16x32_bf16 v[20:23], v[160:163], v[96:99], 0
  v_mfma_f32_16x16x32_bf16 v[24:27], v[172:175], v[96:99], 0
  v_mfma_f32_16x16x32_bf16 v[20:23], v[164:167], v[100:103], v[20:23]
  v_mfma_f32_16x16x32_bf16 v[24:27], v[176:179], v[100:103], v[24:27]
  v_mfma_f32_16x16x32_bf16 v[20:23], v[168:171], v[104:107], v[20:23]
  v_mfma_f32_16x16x32_bf16 v[24:27], v[180:183], v[104:107], v[24:27]
  s_lshl_b32 s48, s20, 10
  v_add_u32 v8, s48, v1
  s_nop 4
  ds_write_b128 v8, v[20:23] offset:4096
  ds_write_b128 v8, v[24:27] offset:8192
  s_waitcnt lgkmcnt(0)
  s_barrier
  s_cmp_ge_u32 s20, 2
  s_cbranch_scc1 standalone__detection_seg_dino__vision_kernel_done
  s_lshl_b32 s48, s20, 12
  v_add_u32 v8, s48, v1
  ds_read_b128 v[64:67], v8 offset:4096
  ds_read_b128 v[68:71], v8 offset:5120
  ds_read_b128 v[72:75], v8 offset:6144
  ds_read_b128 v[76:79], v8 offset:7168
  v_lshlrev_b32 v80, 16, v56
  v_and_b32 v81, 0xffff0000, v56
  v_lshlrev_b32 v82, 16, v57
  v_and_b32 v83, 0xffff0000, v57
  s_waitcnt lgkmcnt(2)
  v_add_f32 v64, v64, v68
  s_waitcnt lgkmcnt(0)
  v_add_f32 v72, v72, v76
  v_add_f32 v64, v64, v72
  v_fma_f32 v64, v64, v13, v80
  v_add_f32 v65, v65, v69
  v_add_f32 v73, v73, v77
  v_add_f32 v65, v65, v73
  v_fma_f32 v65, v65, v13, v81
  v_add_f32 v66, v66, v70
  v_add_f32 v74, v74, v78
  v_add_f32 v66, v66, v74
  v_fma_f32 v66, v66, v13, v82
  v_add_f32 v67, v67, v71
  v_add_f32 v75, v75, v79
  v_add_f32 v67, v67, v75
  v_fma_f32 v67, v67, v13, v83
  v_cvt_pk_bf16_f32 v64, v64, v65
  v_cvt_pk_bf16_f32 v65, v66, v67
  buffer_store_dwordx2 v[64:65], v7, s[44:47], s62 offen sc1
  s_add_u32 s48, s100, s20
  s_cmp_lg_u32 s48, 0
  s_cbranch_scc1 standalone__detection_seg_dino__vision_kernel_spe
  v_mov_b32 v8, s94
  v_mov_b32 v9, 0
  s_mov_b64 exec, 1
  buffer_store_dword v8, v9, s[16:19], 0 offen sc1
standalone__detection_seg_dino__vision_kernel_spe:
standalone__detection_seg_dino__vision_kernel_done:
  s_endpgm
.section .rodata,"a"
.p2align 6
.amdhsa_kernel standalone__detection_seg_dino__vision_kernel
  .amdhsa_next_free_vgpr 448
  .amdhsa_next_free_sgpr 102
  .amdhsa_accum_offset 252
  .amdhsa_group_segment_fixed_size 0
  .amdhsa_kernarg_size 80
  .amdhsa_user_sgpr_count 2
  .amdhsa_user_sgpr_kernarg_segment_ptr 1
  .amdhsa_system_sgpr_workgroup_id_x 1
  .amdhsa_float_denorm_mode_32 3
.end_amdhsa_kernel
```
